```python
import torch

def _softmax(x, axis=-1):
    return torch.softmax(x, dim=axis)
def _gelu(x):
    return torch.nn.functional.gelu(x, approximate="tanh")
def _silu(x):
    return torch.nn.functional.silu(x)
def _sigmoid(x):
    return torch.sigmoid(x)
def _layernorm(x, axis=-1, eps=1e-5):
    m = x.mean(dim=axis, keepdim=True)
    v = x.var(dim=axis, keepdim=True, unbiased=False)
    return (x - m) / torch.sqrt(v + eps)
def _scatter_add(tgt, idx, src, axis=0):
    return tgt.clone().index_add_(axis, idx, src)
def _segment_sum(src, seg, n):
    out = torch.zeros((n,) + src.shape[1:], dtype=src.dtype)
    return out.index_add_(0, seg, src)
def _pad(x, pw):
    flat = tuple(v for pair in reversed(pw) for v in pair)
    return torch.nn.functional.pad(x, flat)

kernel_name = 'sequential_preLN__softmax_full_mha__dense_activation_gelu__prompt'

def setup_inputs():

    _w = (lambda a: (lambda t: t.to(torch.bfloat16) if t.is_floating_point() else t)(torch.as_tensor(a)))
    def _A_setup():
        B, S, D = 1, 2048, 512
        return {
            "x": _w((lambda *s: torch.randn(*s, dtype=torch.bfloat16) * 0.05)(B, S, D)),
            "wqkv": _w((lambda *s: torch.randn(*s, dtype=torch.bfloat16) * 0.05)(D, 3 * D)),
            "wo": _w((lambda *s: torch.randn(*s, dtype=torch.bfloat16) * 0.05)(D, D)),
        }
    _A_in = _A_setup()

    def _B_setup():
        B, S, D, F = 1, 2048, 512, 1376
        return {
            "x": _w((lambda *s: torch.randn(*s, dtype=torch.bfloat16) * 0.05)(B, S, D)),
            "w1": _w((lambda *s: torch.randn(*s, dtype=torch.bfloat16) * 0.8)(D, F) * (D ** -0.5)),
            "b1": _w((lambda *s: torch.randn(*s, dtype=torch.bfloat16) * 0.2)(F) * 0.01),
            "w2": _w((lambda *s: torch.randn(*s, dtype=torch.bfloat16) * 0.2)(F, D) * (F ** -0.5)),
            "b2": _w((lambda *s: torch.randn(*s, dtype=torch.bfloat16) * 0.2)(D) * 0.01),
        }
    _B_in = _B_setup()

    return {
        "A_x": _A_in["x"],
        "A_wqkv": _A_in["wqkv"],
        "A_wo": _A_in["wo"],
        "B_x": _B_in["x"],
        "B_w1": _B_in["w1"],
        "B_b1": _B_in["b1"],
        "B_w2": _B_in["w2"],
        "B_b2": _B_in["b2"],
    }

def reference(A_x, A_wqkv, A_wo, B_x, B_w1, B_b1, B_w2, B_b2):
    def _A_ref(x, wqkv, wo):
        B, S, D = x.shape
        H = 32; Dh = D // H
        qkv = (lambda x, *d: x.permute(*d))((x @ wqkv).reshape(B, S, 3, H, Dh), 2, 0, 3, 1, 4)
        q, k, v = qkv[0], qkv[1], qkv[2]
        scale = Dh ** -0.5
        scores = torch.einsum("bhqd,bhkd->bhqk", q, k) * scale
        p = _softmax(scores, axis=-1)
        o = torch.einsum("bhqk,bhkd->bhqd", p, v)
        return (lambda x, *d: x.permute(*d))(o, 0, 2, 1, 3).reshape(B, S, D) @ wo

    def _B_ref(x, w1, b1, w2, b2):
        h = torch.einsum("bsd,df->bsf", x, w1) + b1
        h = _gelu(h)
        return torch.einsum("bsf,fd->bsd", h, w2) + b2

    x = A_x
    h = x + _A_ref(_layernorm(x, axis=-1), A_wqkv, A_wo)
    h2 = h + _B_ref(_layernorm(h, axis=-1), B_w1, B_b1, B_w2, B_b2)
    return h2
```

```asm
; @launch grid=(256,1,1) block=(512,1,1) lds=163840
.amdgcn_target "amdgcn-amd-amdhsa--gfx950"
.text
.globl sequential_preLN__softmax_full_mha__dense_activation_gelu__prompt_kernel
.p2align 8
.type sequential_preLN__softmax_full_mha__dense_activation_gelu__prompt_kernel,@function
sequential_preLN__softmax_full_mha__dense_activation_gelu__prompt_kernel:
    s_cmp_ge_u32 s2, 256
    s_cbranch_scc1 L_end
    s_load_dwordx16 s[44:59], s[0:1], 0
    s_load_dwordx4 s[60:63], s[0:1], 64
    s_load_dwordx2 s[64:65], s[0:1], 80
    s_getpc_b64 s[4:5]
L_pc:
    v_lshrrev_b32 v4, 6, v0
    s_and_b32 s72, s2, 0xf8
    v_readfirstlane_b32 s3, v4
    v_and_b32 v1, 63, v0
    v_lshl_add_u32 v5, v1, 8, v4
    v_add_u32 v5, s72, v5
    v_lshlrev_b32 v5, 7, v5
    v_min_u32 v5, L_code_end-L_pc-4, v5
    s_mov_b64 exec, 3
    global_load_dword v251, v5, s[4:5]
    s_mov_b64 exec, -1
    s_and_b32 s72, s2, 7
    s_lshr_b32 s73, s2, 3
    s_lshr_b32 s74, s72, 1
    s_lshl_b32 s74, s74, 3
    s_lshr_b32 s100, s73, 2
    s_add_u32 s67, s74, s100
    v_lshrrev_b32 v4, 3, v0
    v_and_b32 v5, 7, v0
    v_lshlrev_b32 v2, 10, v4
    v_lshl_add_u32 v2, v5, 4, v2
    s_lshl_b32 s78, s67, 16
    s_add_u32 s79, s100, 0
    s_and_b32 s79, s79, 3
    s_lshl_b32 s79, s79, 8
    s_add_u32 s86, s78, s79
    s_add_u32 s79, s100, 1
    s_and_b32 s79, s79, 3
    s_lshl_b32 s79, s79, 8
    s_add_u32 s87, s78, s79
    s_add_u32 s79, s100, 2
    s_and_b32 s79, s79, 3
    s_lshl_b32 s79, s79, 8
    s_add_u32 s88, s78, s79
    s_add_u32 s79, s100, 3
    s_and_b32 s79, s79, 3
    s_lshl_b32 s79, s79, 8
    s_add_u32 s89, s78, s79
    s_mov_b32 s10, 2097152
    s_mov_b32 s11, 0x00020000
    s_lshl_b32 s76, s2, 1
    s_lshr_b32 s77, s3, 2
    s_add_u32 s76, s76, s77
    s_mul_i32 s76, s76, 3072
    s_and_b32 s77, s3, 3
    s_lshl_b32 s77, s77, 8
    s_add_u32 s76, s76, s77
    s_waitcnt lgkmcnt(0)
    s_mov_b64 s[8:9], s[44:45]
    s_add_u32 s4, s46, s76
    s_addc_u32 s5, s47, 0
    buffer_load_dwordx4 v[16:19], v2, s[8:11], s86 offen offset:0
    buffer_load_dwordx4 v[20:23], v2, s[8:11], s86 offen offset:128
    buffer_load_dwordx4 v[24:27], v2, s[8:11], s87 offen offset:0
    buffer_load_dwordx4 v[28:31], v2, s[8:11], s87 offen offset:128
    buffer_load_dwordx4 v[32:35], v2, s[8:11], s88 offen offset:0
    buffer_load_dwordx4 v[36:39], v2, s[8:11], s88 offen offset:128
    buffer_load_dwordx4 v[40:43], v2, s[8:11], s89 offen offset:0
    buffer_load_dwordx4 v[44:47], v2, s[8:11], s89 offen offset:128
    s_load_dword s70, s[64:65], 0
    s_mov_b32 s12, s46
    s_mov_b32 s13, s47
    s_mov_b32 s14, 1572864
    s_mov_b32 s15, 0x00020000
    s_and_b32 s74, s72, 1
    s_and_b32 s75, s73, 3
    s_lshl_b32 s75, s75, 1
    s_add_u32 s66, s74, s75
    s_lshl_b32 s74, s72, 2
    s_and_b32 s75, s73, 3
    s_add_u32 s68, s74, s75
    s_lshr_b32 s69, s73, 2
    v_and_b32 v6, 31, v4
    v_xor_b32 v6, v6, v5
    v_lshlrev_b32 v6, 4, v6
    v_lshl_add_u32 v6, v5, 9, v6
    v_lshrrev_b32 v4, 5, v4
    v_lshl_add_u32 v3, v4, 15, v6
    v_mov_b32 v60, 0x3f803f80
    v_mov_b32 v61, 0x00003f80
    v_mov_b32 v62, 0x3f800000
    v_mov_b32 v56, 0
    v_mov_b32 v57, 0
    s_cmp_lt_u32 s3, 4
    s_cbranch_scc1 L_p1_a
    s_lshr_b32 s77, s2, 3
    s_lshl_b32 s77, s77, 2
    s_and_b32 s79, s3, 3
    s_add_u32 s77, s77, s79
    s_mul_i32 s77, s77, 12288
    s_and_b32 s79, s66, 1
    s_lshl_b32 s79, s79, 7
    s_add_u32 s77, s77, s79
    v_lshrrev_b32 v10, 2, v1
    v_mul_u32_u24 v10, 3072, v10
    v_and_b32 v11, 3, v1
    v_lshl_add_u32 v10, v11, 8, v10
    s_mov_b64 exec, 0xffff
    buffer_load_dword v251, v10, s[12:15], s77 offen offset:1024
    buffer_load_dword v251, v10, s[12:15], s77 offen offset:2048
    s_mov_b64 exec, -1
    s_lshl_b32 s76, s66, 7
    v_lshrrev_b32 v10, 3, v1
    v_and_b32 v11, 7, v1
    v_lshlrev_b32 v13, 1, v10
    v_and_b32 v13, 4, v13
    v_xor_b32 v11, v11, v13
    v_mul_u32_u24 v10, 3072, v10
    v_lshl_add_u32 v10, v11, 4, v10
    v_add_u32 v13, s76, v10
    s_and_b32 s97, s3, 3
    s_mul_i32 s72, s97, 98304
    s_lshl_b32 s97, s97, 12
    s_add_u32 s79, s100, 0
    s_and_b32 s79, s79, 3
    s_mul_i32 s79, s79, 393216
    s_add_u32 s86, s72, s79
    s_add_u32 s79, s100, 1
    s_and_b32 s79, s79, 3
    s_mul_i32 s79, s79, 393216
    s_add_u32 s87, s72, s79
    s_add_u32 s79, s100, 2
    s_and_b32 s79, s79, 3
    s_mul_i32 s79, s79, 393216
    s_add_u32 s88, s72, s79
    s_add_u32 s79, s100, 3
    s_and_b32 s79, s79, 3
    s_mul_i32 s79, s79, 393216
    s_add_u32 s89, s72, s79
    s_waitcnt vmcnt(9)
.p2align 3
    v_dot2_f32_bf16 v56, v16, v60, v56
    v_dot2_f32_bf16 v57, v16, v16, v57
    v_dot2_f32_bf16 v56, v17, v60, v56
    v_dot2_f32_bf16 v57, v17, v17, v57
    v_dot2_f32_bf16 v56, v18, v60, v56
    v_dot2_f32_bf16 v57, v18, v18, v57
    v_dot2_f32_bf16 v56, v19, v60, v56
    v_dot2_f32_bf16 v57, v19, v19, v57
    s_waitcnt vmcnt(8)
.p2align 3
    v_dot2_f32_bf16 v56, v20, v60, v56
    v_dot2_f32_bf16 v57, v20, v20, v57
    v_dot2_f32_bf16 v56, v21, v60, v56
    v_dot2_f32_bf16 v57, v21, v21, v57
    v_dot2_f32_bf16 v56, v22, v60, v56
    v_dot2_f32_bf16 v57, v22, v22, v57
    v_dot2_f32_bf16 v56, v23, v60, v56
    v_dot2_f32_bf16 v57, v23, v23, v57
    s_waitcnt vmcnt(7)
.p2align 3
    v_dot2_f32_bf16 v56, v24, v60, v56
    v_dot2_f32_bf16 v57, v24, v24, v57
    v_dot2_f32_bf16 v56, v25, v60, v56
    v_dot2_f32_bf16 v57, v25, v25, v57
    v_dot2_f32_bf16 v56, v26, v60, v56
    v_dot2_f32_bf16 v57, v26, v26, v57
    v_dot2_f32_bf16 v56, v27, v60, v56
    v_dot2_f32_bf16 v57, v27, v27, v57
    s_waitcnt vmcnt(6)
.p2align 3
    v_dot2_f32_bf16 v56, v28, v60, v56
    v_dot2_f32_bf16 v57, v28, v28, v57
    v_dot2_f32_bf16 v56, v29, v60, v56
    v_dot2_f32_bf16 v57, v29, v29, v57
    v_dot2_f32_bf16 v56, v30, v60, v56
    v_dot2_f32_bf16 v57, v30, v30, v57
    v_dot2_f32_bf16 v56, v31, v60, v56
    v_dot2_f32_bf16 v57, v31, v31, v57
    s_waitcnt vmcnt(5)
.p2align 3
    v_dot2_f32_bf16 v56, v32, v60, v56
    v_dot2_f32_bf16 v57, v32, v32, v57
    v_dot2_f32_bf16 v56, v33, v60, v56
    v_dot2_f32_bf16 v57, v33, v33, v57
    v_dot2_f32_bf16 v56, v34, v60, v56
    v_dot2_f32_bf16 v57, v34, v34, v57
    v_dot2_f32_bf16 v56, v35, v60, v56
    v_dot2_f32_bf16 v57, v35, v35, v57
    s_waitcnt vmcnt(4)
.p2align 3
    v_dot2_f32_bf16 v56, v36, v60, v56
    v_dot2_f32_bf16 v57, v36, v36, v57
    v_dot2_f32_bf16 v56, v37, v60, v56
    v_dot2_f32_bf16 v57, v37, v37, v57
    v_dot2_f32_bf16 v56, v38, v60, v56
    v_dot2_f32_bf16 v57, v38, v38, v57
    v_dot2_f32_bf16 v56, v39, v60, v56
    v_dot2_f32_bf16 v57, v39, v39, v57
    s_waitcnt vmcnt(3)
.p2align 3
    v_dot2_f32_bf16 v56, v40, v60, v56
    v_dot2_f32_bf16 v57, v40, v40, v57
    v_dot2_f32_bf16 v56, v41, v60, v56
    v_dot2_f32_bf16 v57, v41, v41, v57
    v_dot2_f32_bf16 v56, v42, v60, v56
    v_dot2_f32_bf16 v57, v42, v42, v57
    v_dot2_f32_bf16 v56, v43, v60, v56
    v_dot2_f32_bf16 v57, v43, v43, v57
    s_waitcnt vmcnt(2)
.p2align 3
    v_dot2_f32_bf16 v56, v44, v60, v56
    v_dot2_f32_bf16 v57, v44, v44, v57
    v_dot2_f32_bf16 v56, v45, v60, v56
    v_dot2_f32_bf16 v57, v45, v45, v57
    v_dot2_f32_bf16 v56, v46, v60, v56
    v_dot2_f32_bf16 v57, v46, v46, v57
    v_dot2_f32_bf16 v56, v47, v60, v56
    v_dot2_f32_bf16 v57, v47, v47, v57
    s_branch L_p1_norm
L_p1_a:
    s_mov_b32 s28, s64
    s_mov_b32 s29, s65
    s_mov_b32 s30, 39845888
    s_mov_b32 s31, 0x00020000
    s_mov_b32 s16, s48
    s_mov_b32 s17, s49
    s_mov_b32 s18, 524288
    s_mov_b32 s19, 0x00020000
    s_mov_b32 s20, s52
    s_mov_b32 s21, s53
    s_mov_b32 s22, 1409024
    s_mov_b32 s23, 0x00020000
    s_mov_b32 s36, s54
    s_mov_b32 s37, s55
    s_mov_b32 s38, 2752
    s_mov_b32 s39, 0x00020000
    s_mov_b32 s24, s56
    s_mov_b32 s25, s57
    s_mov_b32 s26, 1409024
    s_mov_b32 s27, 0x00020000
    s_mov_b32 s40, s58
    s_mov_b32 s41, s59
    s_mov_b32 s42, 1024
    s_mov_b32 s43, 0x00020000
    s_mov_b32 s32, s60
    s_mov_b32 s33, s61
    s_mov_b32 s34, 2097152
    s_mov_b32 s35, 0x00020000
    s_min_u32 s74, s69, 3
    s_mul_i32 s71, s69, 5
    s_add_u32 s71, s71, s74
    s_cmp_lt_u32 s69, 3
    s_cselect_b32 s92, 6, 5
    s_lshl_b32 s76, s69, 7
    s_lshl_b32 s77, s68, 16
    s_add_u32 s83, s77, s76
    v_lshlrev_b32 v246, 4, v1
    v_lshlrev_b32 v249, 2, v1
    s_and_b32 s72, s3, 2
    s_lshl_b32 s72, s72, 13
    s_and_b32 s73, s3, 1
    s_lshl_b32 s73, s73, 2
    v_and_b32 v10, 31, v1
    v_lshlrev_b32 v10, 8, v10
    v_lshrrev_b32 v11, 5, v1
    v_xor_b32 v11, v11, v1
    v_and_b32 v11, 1, v11
    v_lshl_add_u32 v10, v11, 7, v10
    v_add_u32 v10, s72, v10
    v_and_b32 v11, 7, v1
    v_xor_b32 v11, s73, v11
    v_xor_b32 v240, 0, v11
    v_lshl_add_u32 v240, v240, 4, v10
    v_xor_b32 v241, 1, v11
    v_lshl_add_u32 v241, v241, 4, v10
    v_xor_b32 v242, 2, v11
    v_lshl_add_u32 v242, v242, 4, v10
    v_xor_b32 v243, 3, v11
    v_lshl_add_u32 v243, v243, 4, v10
    v_lshrrev_b32 v10, 3, v0
    v_xor_b32 v11, v10, v0
    v_and_b32 v11, 7, v11
    v_lshlrev_b32 v11, 4, v11
    v_lshl_add_u32 v11, v10, 8, v11
    v_and_b32 v10, 1, v10
    v_lshl_add_u32 v244, v10, 7, v11
    v_xor_b32 v245, 128, v244
    s_and_b32 s72, s3, 3
    s_lshl_b32 s74, s66, 2
    s_add_u32 s74, s74, s72
    s_lshl_b32 s74, s74, 17
    s_add_u32 s74, s74, 1048576
    v_and_b32 v10, 15, v1
    v_lshrrev_b32 v11, 5, v1
    v_lshl_add_u32 v10, v11, 4, v10
    v_lshl_add_u32 v14, v10, 4, s74
    v_add_u32 v15, s74, v246
    s_lshr_b32 s73, s3, 2
    s_mul_i32 s81, s73, 98304
    s_lshl_b32 s62, s67, 12
    s_add_u32 s63, s62, 4096
    s_and_b32 s63, s63, 0x1ffff
    s_and_b32 s74, s62, 0x7fff
    s_cmp_ge_u32 s81, s74
    s_cselect_b32 s75, 4096, 0
    s_add_u32 s81, s81, s75
    s_and_b32 s74, s62, 0x18000
    s_add_u32 s81, s81, s74
    s_and_b32 s81, s81, 0x1ffff
    s_mov_b32 s84, 0xffff
    s_mov_b32 s85, 0xffff
    v_and_b32 v10, 0x1b, v1
    v_cmp_eq_u32 vcc, 16, v10
    v_mov_b32 v10, 0x3f803f80
    v_mov_b32 v11, 0
    v_cndmask_b32 v214, v11, v10, vcc
    s_lshl_b32 s74, s3, 10
    v_add_u32 v215, s74, v246
    s_lshl_b32 s74, s73, 3
    s_add_u32 s74, s74, s66
    s_lshl_b32 s74, s74, 2
    s_add_u32 s74, s74, s72
    s_lshl_b32 s74, s74, 10
    s_and_b32 s75, s74, 0xffffe000
    s_add_u32 s74, s74, s75
    s_add_u32 s82, s74, 6291456
    s_lshl_b32 s74, s68, 20
    s_lshl_b32 s75, s69, 7
    s_add_u32 s74, s74, s75
    s_and_b32 s75, s3, 1
    s_lshl_b32 s75, s75, 13
    s_add_u32 s74, s74, s75
    s_add_u32 s74, s74, 6946816
    s_load_dword s93, s[64:65], s74
    s_lshl_b32 s75, s3, 7
    s_lshl_b32 s74, s66, 9
    s_add_u32 s74, s74, s75
    s_add_u32 s74, s74, 16384
    s_and_b32 s75, s67, 1
    s_lshl_b32 s75, s75, 6
    s_add_u32 s74, s74, s75
    s_load_dword s93, s[64:65], s74
    s_lshl_b32 s74, s2, 2
    s_add_u32 s74, s74, 32768
    s_load_dword s93, s[64:65], s74
    s_lshl_b32 s74, s3, 1
    s_add_u32 s74, s74, s71
    s_min_u32 s74, s74, 41
    s_lshl_b32 s74, s74, 6
    s_add_u32 s75, s74, 64
    s_load_dword s93, s[54:55], s74
    s_load_dword s93, s[54:55], s75
    s_and_b32 s74, s3, 1
    s_lshl_b32 s74, s74, 6
    s_add_u32 s74, s74, s76
    s_load_dword s93, s[58:59], s74
    s_bfe_u32 s72, s3, 0x10001
    v_bfe_u32 v10, v1, 2, 2
    v_lshrrev_b32 v11, 1, v10
    v_xor_b32 v11, s72, v11
    v_lshlrev_b32 v11, 6, v11
    v_lshl_add_u32 v11, v10, 7, v11
    v_bfe_u32 v10, v1, 4, 1
    v_lshl_add_u32 v11, v10, 5, v11
    v_and_b32 v10, 1, v1
    v_lshl_add_u32 v11, v10, 4, v11
    v_bfe_u32 v10, v1, 1, 1
    v_lshl_add_u32 v11, v10, 3, v11
    v_lshrrev_b32 v10, 5, v1
    v_lshl_add_u32 v8, v10, 10, v11
    v_add_u32 v8, 65536, v8
    v_add_u32 v9, 49152, v8
    s_and_b32 s72, s3, 1
    s_lshl_b32 s72, s72, 15
    v_lshrrev_b32 v10, 5, v1
    v_add_u32 v10, 0, v10
    v_and_b32 v11, 31, v1
    v_xor_b32 v11, v11, v10
    v_lshlrev_b32 v11, 4, v11
    v_lshl_add_u32 v11, v10, 9, v11
    v_add_u32 v4, s72, v11
    v_lshrrev_b32 v10, 5, v1
    v_add_u32 v10, 2, v10
    v_and_b32 v11, 31, v1
    v_xor_b32 v11, v11, v10
    v_lshlrev_b32 v11, 4, v11
    v_lshl_add_u32 v11, v10, 9, v11
    v_add_u32 v5, s72, v11
    v_lshrrev_b32 v10, 5, v1
    v_add_u32 v10, 4, v10
    v_and_b32 v11, 31, v1
    v_xor_b32 v11, v11, v10
    v_lshlrev_b32 v11, 4, v11
    v_lshl_add_u32 v11, v10, 9, v11
    v_add_u32 v6, s72, v11
    v_lshrrev_b32 v10, 5, v1
    v_add_u32 v10, 6, v10
    v_and_b32 v11, 31, v1
    v_xor_b32 v11, v11, v10
    v_lshlrev_b32 v11, 4, v11
    v_lshl_add_u32 v11, v10, 9, v11
    v_add_u32 v7, s72, v11
    s_lshl_b32 s76, s66, 7
    v_lshrrev_b32 v10, 3, v1
    v_and_b32 v11, 7, v1
    v_lshlrev_b32 v13, 1, v10
    v_and_b32 v13, 4, v13
    v_xor_b32 v11, v11, v13
    v_mul_u32_u24 v10, 3072, v10
    v_lshl_add_u32 v10, v11, 4, v10
    v_add_u32 v13, s76, v10
    s_and_b32 s97, s3, 3
    s_mul_i32 s72, s97, 98304
    s_lshl_b32 s97, s97, 12
    s_add_u32 s79, s100, 0
    s_and_b32 s79, s79, 3
    s_mul_i32 s79, s79, 393216
    s_add_u32 s86, s72, s79
    s_add_u32 s79, s100, 1
    s_and_b32 s79, s79, 3
    s_mul_i32 s79, s79, 393216
    s_add_u32 s87, s72, s79
    s_add_u32 s79, s100, 2
    s_and_b32 s79, s79, 3
    s_mul_i32 s79, s79, 393216
    s_add_u32 s88, s72, s79
    s_add_u32 s79, s100, 3
    s_and_b32 s79, s79, 3
    s_mul_i32 s79, s79, 393216
    s_add_u32 s89, s72, s79
    s_and_b32 s72, s3, 1
    s_lshr_b32 s73, s3, 1
    v_bfe_u32 v10, v1, 2, 2
    v_lshrrev_b32 v11, 1, v10
    v_xor_b32 v11, s72, v11
    v_lshlrev_b32 v11, 6, v11
    v_lshl_add_u32 v11, v10, 7, v11
    v_bfe_u32 v10, v1, 4, 1
    v_lshl_add_u32 v11, v10, 5, v11
    v_and_b32 v10, 3, v1
    v_lshl_add_u32 v11, v10, 3, v11
    v_lshrrev_b32 v10, 5, v1
    v_lshl_add_u32 v12, v10, 10, v11
    s_lshl_b32 s79, s73, 15
    v_add_u32 v12, s79, v12
    v_and_b32 v10, 0x33, v1
    v_bfe_u32 v11, v1, 2, 1
    v_lshl_add_u32 v10, v11, 3, v10
    v_bfe_u32 v11, v1, 3, 1
    v_lshl_add_u32 v10, v11, 2, v10
    v_lshlrev_b32 v208, 4, v10
    v_and_b32 v10, 15, v1
    v_lshlrev_b32 v10, 4, v10
    v_lshrrev_b32 v11, 5, v1
    v_lshl_add_u32 v10, v11, 8, v10
    v_bfe_u32 v11, v1, 4, 1
    v_lshl_add_u32 v209, v11, 17, v10
    s_lshl_b32 s74, s72, 12
    s_lshl_b32 s75, s73, 11
    s_add_u32 s74, s74, s75
    v_add_u32 v210, s74, v246
    v_mov_b32 v212, 0x3eb8aa3b
    v_mov_b32 v213, v212
    s_lshl_b32 s74, s66, 1
    s_add_u32 s74, s74, s73
    s_lshl_b32 s74, s74, 18
    s_lshl_b32 s75, s67, 1
    s_add_u32 s75, s75, s72
    s_lshl_b32 s75, s75, 11
    s_add_u32 s74, s74, s75
    s_add_u32 s74, s74, 1048576
    s_add_u32 s75, s74, 0x20000
    s_waitcnt vmcnt(7)
.p2align 3
    v_dot2_f32_bf16 v56, v16, v60, v56
    v_dot2_f32_bf16 v57, v16, v16, v57
    v_dot2_f32_bf16 v56, v17, v60, v56
    v_dot2_f32_bf16 v57, v17, v17, v57
    v_dot2_f32_bf16 v56, v18, v60, v56
    v_dot2_f32_bf16 v57, v18, v18, v57
    v_dot2_f32_bf16 v56, v19, v60, v56
    v_dot2_f32_bf16 v57, v19, v19, v57
    s_waitcnt vmcnt(6)
.p2align 3
    v_dot2_f32_bf16 v56, v20, v60, v56
    v_dot2_f32_bf16 v57, v20, v20, v57
    v_dot2_f32_bf16 v56, v21, v60, v56
    v_dot2_f32_bf16 v57, v21, v21, v57
    v_dot2_f32_bf16 v56, v22, v60, v56
    v_dot2_f32_bf16 v57, v22, v22, v57
    v_dot2_f32_bf16 v56, v23, v60, v56
    v_dot2_f32_bf16 v57, v23, v23, v57
    s_waitcnt vmcnt(5)
.p2align 3
    v_dot2_f32_bf16 v56, v24, v60, v56
    v_dot2_f32_bf16 v57, v24, v24, v57
    v_dot2_f32_bf16 v56, v25, v60, v56
    v_dot2_f32_bf16 v57, v25, v25, v57
    v_dot2_f32_bf16 v56, v26, v60, v56
    v_dot2_f32_bf16 v57, v26, v26, v57
    v_dot2_f32_bf16 v56, v27, v60, v56
    v_dot2_f32_bf16 v57, v27, v27, v57
    s_waitcnt vmcnt(4)
.p2align 3
    v_dot2_f32_bf16 v56, v28, v60, v56
    v_dot2_f32_bf16 v57, v28, v28, v57
    v_dot2_f32_bf16 v56, v29, v60, v56
    v_dot2_f32_bf16 v57, v29, v29, v57
    v_dot2_f32_bf16 v56, v30, v60, v56
    v_dot2_f32_bf16 v57, v30, v30, v57
    v_dot2_f32_bf16 v56, v31, v60, v56
    v_dot2_f32_bf16 v57, v31, v31, v57
    s_waitcnt vmcnt(3)
.p2align 3
    v_dot2_f32_bf16 v56, v32, v60, v56
    v_dot2_f32_bf16 v57, v32, v32, v57
    v_dot2_f32_bf16 v56, v33, v60, v56
    v_dot2_f32_bf16 v57, v33, v33, v57
    v_dot2_f32_bf16 v56, v34, v60, v56
    v_dot2_f32_bf16 v57, v34, v34, v57
    v_dot2_f32_bf16 v56, v35, v60, v56
    v_dot2_f32_bf16 v57, v35, v35, v57
    s_waitcnt vmcnt(2)
.p2align 3
    v_dot2_f32_bf16 v56, v36, v60, v56
    v_dot2_f32_bf16 v57, v36, v36, v57
    v_dot2_f32_bf16 v56, v37, v60, v56
    v_dot2_f32_bf16 v57, v37, v37, v57
    v_dot2_f32_bf16 v56, v38, v60, v56
    v_dot2_f32_bf16 v57, v38, v38, v57
    v_dot2_f32_bf16 v56, v39, v60, v56
    v_dot2_f32_bf16 v57, v39, v39, v57
    s_waitcnt vmcnt(1)
.p2align 3
    v_dot2_f32_bf16 v56, v40, v60, v56
    v_dot2_f32_bf16 v57, v40, v40, v57
    v_dot2_f32_bf16 v56, v41, v60, v56
    v_dot2_f32_bf16 v57, v41, v41, v57
    v_dot2_f32_bf16 v56, v42, v60, v56
    v_dot2_f32_bf16 v57, v42, v42, v57
    v_dot2_f32_bf16 v56, v43, v60, v56
    v_dot2_f32_bf16 v57, v43, v43, v57
    s_waitcnt vmcnt(0)
.p2align 3
    v_dot2_f32_bf16 v56, v44, v60, v56
    v_dot2_f32_bf16 v57, v44, v44, v57
    v_dot2_f32_bf16 v56, v45, v60, v56
    v_dot2_f32_bf16 v57, v45, v45, v57
    v_dot2_f32_bf16 v56, v46, v60, v56
    v_dot2_f32_bf16 v57, v46, v46, v57
    v_dot2_f32_bf16 v56, v47, v60, v56
    v_dot2_f32_bf16 v57, v47, v47, v57
L_p1_norm:
    s_nop 1
    s_nop 0
    v_add_f32_dpp v56, v56, v56 quad_perm:[1,0,3,2] row_mask:0xf bank_mask:0xf
    v_add_f32_dpp v57, v57, v57 quad_perm:[1,0,3,2] row_mask:0xf bank_mask:0xf
    s_nop 0
    v_add_f32_dpp v56, v56, v56 quad_perm:[2,3,0,1] row_mask:0xf bank_mask:0xf
    v_add_f32_dpp v57, v57, v57 quad_perm:[2,3,0,1] row_mask:0xf bank_mask:0xf
    s_nop 0
    v_add_f32_dpp v56, v56, v56 row_half_mirror row_mask:0xf bank_mask:0xf
    v_add_f32_dpp v57, v57, v57 row_half_mirror row_mask:0xf bank_mask:0xf
    v_mul_f32 v56, 0xbb000000, v56
    v_mul_f32 v58, v56, v56
    v_mul_f32 v57, 0x3b000000, v57
    v_sub_f32 v57, v57, v58
    v_max_f32 v57, 0, v57
    v_add_f32 v57, 0x3727c5ac, v57
    v_rsq_f32 v58, v57
    s_nop 0
    v_mov_b32 v59, v58
.p2align 3
    v_dot2_f32_bf16 v48, v16, v61, v56
    v_dot2_f32_bf16 v49, v16, v62, v56
    v_dot2_f32_bf16 v50, v17, v61, v56
    v_dot2_f32_bf16 v51, v17, v62, v56
    v_dot2_f32_bf16 v52, v18, v61, v56
    v_dot2_f32_bf16 v53, v18, v62, v56
    v_dot2_f32_bf16 v54, v19, v61, v56
    v_dot2_f32_bf16 v55, v19, v62, v56
    v_pk_mul_f32 v[48:49], v[48:49], v[58:59]
    v_pk_mul_f32 v[50:51], v[50:51], v[58:59]
    v_pk_mul_f32 v[52:53], v[52:53], v[58:59]
    v_pk_mul_f32 v[54:55], v[54:55], v[58:59]
    v_cvt_pk_bf16_f32 v16, v48, v49
    v_cvt_pk_bf16_f32 v17, v50, v51
    v_cvt_pk_bf16_f32 v18, v52, v53
    v_cvt_pk_bf16_f32 v19, v54, v55
    ds_write_b128 v3, v[16:19] offset:0
.p2align 3
    v_dot2_f32_bf16 v48, v20, v61, v56
    v_dot2_f32_bf16 v49, v20, v62, v56
    v_dot2_f32_bf16 v50, v21, v61, v56
    v_dot2_f32_bf16 v51, v21, v62, v56
    v_dot2_f32_bf16 v52, v22, v61, v56
    v_dot2_f32_bf16 v53, v22, v62, v56
    v_dot2_f32_bf16 v54, v23, v61, v56
    v_dot2_f32_bf16 v55, v23, v62, v56
    v_pk_mul_f32 v[48:49], v[48:49], v[58:59]
    v_pk_mul_f32 v[50:51], v[50:51], v[58:59]
    v_pk_mul_f32 v[52:53], v[52:53], v[58:59]
    v_pk_mul_f32 v[54:55], v[54:55], v[58:59]
    v_cvt_pk_bf16_f32 v20, v48, v49
    v_cvt_pk_bf16_f32 v21, v50, v51
    v_cvt_pk_bf16_f32 v22, v52, v53
    v_cvt_pk_bf16_f32 v23, v54, v55
    ds_write_b128 v3, v[20:23] offset:4096
.p2align 3
    v_dot2_f32_bf16 v48, v24, v61, v56
    v_dot2_f32_bf16 v49, v24, v62, v56
    v_dot2_f32_bf16 v50, v25, v61, v56
    v_dot2_f32_bf16 v51, v25, v62, v56
    v_dot2_f32_bf16 v52, v26, v61, v56
    v_dot2_f32_bf16 v53, v26, v62, v56
    v_dot2_f32_bf16 v54, v27, v61, v56
    v_dot2_f32_bf16 v55, v27, v62, v56
    v_pk_mul_f32 v[48:49], v[48:49], v[58:59]
    v_pk_mul_f32 v[50:51], v[50:51], v[58:59]
    v_pk_mul_f32 v[52:53], v[52:53], v[58:59]
    v_pk_mul_f32 v[54:55], v[54:55], v[58:59]
    v_cvt_pk_bf16_f32 v24, v48, v49
    v_cvt_pk_bf16_f32 v25, v50, v51
    v_cvt_pk_bf16_f32 v26, v52, v53
    v_cvt_pk_bf16_f32 v27, v54, v55
    ds_write_b128 v3, v[24:27] offset:8192
.p2align 3
    v_dot2_f32_bf16 v48, v28, v61, v56
    v_dot2_f32_bf16 v49, v28, v62, v56
    v_dot2_f32_bf16 v50, v29, v61, v56
    v_dot2_f32_bf16 v51, v29, v62, v56
    v_dot2_f32_bf16 v52, v30, v61, v56
    v_dot2_f32_bf16 v53, v30, v62, v56
    v_dot2_f32_bf16 v54, v31, v61, v56
    v_dot2_f32_bf16 v55, v31, v62, v56
    v_pk_mul_f32 v[48:49], v[48:49], v[58:59]
    v_pk_mul_f32 v[50:51], v[50:51], v[58:59]
    v_pk_mul_f32 v[52:53], v[52:53], v[58:59]
    v_pk_mul_f32 v[54:55], v[54:55], v[58:59]
    v_cvt_pk_bf16_f32 v28, v48, v49
    v_cvt_pk_bf16_f32 v29, v50, v51
    v_cvt_pk_bf16_f32 v30, v52, v53
    v_cvt_pk_bf16_f32 v31, v54, v55
    ds_write_b128 v3, v[28:31] offset:12288
.p2align 3
    v_dot2_f32_bf16 v48, v32, v61, v56
    v_dot2_f32_bf16 v49, v32, v62, v56
    v_dot2_f32_bf16 v50, v33, v61, v56
    v_dot2_f32_bf16 v51, v33, v62, v56
    v_dot2_f32_bf16 v52, v34, v61, v56
    v_dot2_f32_bf16 v53, v34, v62, v56
    v_dot2_f32_bf16 v54, v35, v61, v56
    v_dot2_f32_bf16 v55, v35, v62, v56
    v_pk_mul_f32 v[48:49], v[48:49], v[58:59]
    v_pk_mul_f32 v[50:51], v[50:51], v[58:59]
    v_pk_mul_f32 v[52:53], v[52:53], v[58:59]
    v_pk_mul_f32 v[54:55], v[54:55], v[58:59]
    v_cvt_pk_bf16_f32 v32, v48, v49
    v_cvt_pk_bf16_f32 v33, v50, v51
    v_cvt_pk_bf16_f32 v34, v52, v53
    v_cvt_pk_bf16_f32 v35, v54, v55
    ds_write_b128 v3, v[32:35] offset:16384
.p2align 3
    v_dot2_f32_bf16 v48, v36, v61, v56
    v_dot2_f32_bf16 v49, v36, v62, v56
    v_dot2_f32_bf16 v50, v37, v61, v56
    v_dot2_f32_bf16 v51, v37, v62, v56
    v_dot2_f32_bf16 v52, v38, v61, v56
    v_dot2_f32_bf16 v53, v38, v62, v56
    v_dot2_f32_bf16 v54, v39, v61, v56
    v_dot2_f32_bf16 v55, v39, v62, v56
    v_pk_mul_f32 v[48:49], v[48:49], v[58:59]
    v_pk_mul_f32 v[50:51], v[50:51], v[58:59]
    v_pk_mul_f32 v[52:53], v[52:53], v[58:59]
    v_pk_mul_f32 v[54:55], v[54:55], v[58:59]
    v_cvt_pk_bf16_f32 v36, v48, v49
    v_cvt_pk_bf16_f32 v37, v50, v51
    v_cvt_pk_bf16_f32 v38, v52, v53
    v_cvt_pk_bf16_f32 v39, v54, v55
    ds_write_b128 v3, v[36:39] offset:20480
.p2align 3
    v_dot2_f32_bf16 v48, v40, v61, v56
    v_dot2_f32_bf16 v49, v40, v62, v56
    v_dot2_f32_bf16 v50, v41, v61, v56
    v_dot2_f32_bf16 v51, v41, v62, v56
    v_dot2_f32_bf16 v52, v42, v61, v56
    v_dot2_f32_bf16 v53, v42, v62, v56
    v_dot2_f32_bf16 v54, v43, v61, v56
    v_dot2_f32_bf16 v55, v43, v62, v56
    v_pk_mul_f32 v[48:49], v[48:49], v[58:59]
    v_pk_mul_f32 v[50:51], v[50:51], v[58:59]
    v_pk_mul_f32 v[52:53], v[52:53], v[58:59]
    v_pk_mul_f32 v[54:55], v[54:55], v[58:59]
    v_cvt_pk_bf16_f32 v40, v48, v49
    v_cvt_pk_bf16_f32 v41, v50, v51
    v_cvt_pk_bf16_f32 v42, v52, v53
    v_cvt_pk_bf16_f32 v43, v54, v55
    ds_write_b128 v3, v[40:43] offset:24576
.p2align 3
    v_dot2_f32_bf16 v48, v44, v61, v56
    v_dot2_f32_bf16 v49, v44, v62, v56
    v_dot2_f32_bf16 v50, v45, v61, v56
    v_dot2_f32_bf16 v51, v45, v62, v56
    v_dot2_f32_bf16 v52, v46, v61, v56
    v_dot2_f32_bf16 v53, v46, v62, v56
    v_dot2_f32_bf16 v54, v47, v61, v56
    v_dot2_f32_bf16 v55, v47, v62, v56
    v_pk_mul_f32 v[48:49], v[48:49], v[58:59]
    v_pk_mul_f32 v[50:51], v[50:51], v[58:59]
    v_pk_mul_f32 v[52:53], v[52:53], v[58:59]
    v_pk_mul_f32 v[54:55], v[54:55], v[58:59]
    v_cvt_pk_bf16_f32 v44, v48, v49
    v_cvt_pk_bf16_f32 v45, v50, v51
    v_cvt_pk_bf16_f32 v46, v52, v53
    v_cvt_pk_bf16_f32 v47, v54, v55
    ds_write_b128 v3, v[44:47] offset:28672
    s_cmp_lt_u32 s3, 4
    s_cbranch_scc1 L_p1_compute
    s_waitcnt lgkmcnt(0)
    s_barrier
    s_add_u32 m0, s97, 114688
    s_add_u32 s79, s89, 1024
    buffer_load_dwordx4 v13, s[12:15], s79 offen  lds
    s_add_u32 m0, s97, 115712
    s_add_u32 s79, s89, 25600
    buffer_load_dwordx4 v13, s[12:15], s79 offen  lds
    s_add_u32 m0, s97, 116736
    s_add_u32 s79, s89, 50176
    buffer_load_dwordx4 v13, s[12:15], s79 offen  lds
    s_add_u32 m0, s97, 117760
    s_add_u32 s79, s89, 74752
    buffer_load_dwordx4 v13, s[12:15], s79 offen  lds
    s_add_u32 m0, s97, 131072
    s_add_u32 s79, s86, 2048
    buffer_load_dwordx4 v13, s[12:15], s79 offen  lds
    s_add_u32 m0, s97, 132096
    s_add_u32 s79, s86, 26624
    buffer_load_dwordx4 v13, s[12:15], s79 offen  lds
    s_add_u32 m0, s97, 133120
    s_add_u32 s79, s86, 51200
    buffer_load_dwordx4 v13, s[12:15], s79 offen  lds
    s_add_u32 m0, s97, 134144
    s_add_u32 s79, s86, 75776
    buffer_load_dwordx4 v13, s[12:15], s79 offen  lds
    s_barrier
    s_add_u32 m0, s97, 147456
    s_add_u32 s79, s87, 2048
    buffer_load_dwordx4 v13, s[12:15], s79 offen  lds
    s_add_u32 m0, s97, 148480
    s_add_u32 s79, s87, 26624
    buffer_load_dwordx4 v13, s[12:15], s79 offen  lds
    s_add_u32 m0, s97, 149504
    s_add_u32 s79, s87, 51200
    buffer_load_dwordx4 v13, s[12:15], s79 offen  lds
    s_add_u32 m0, s97, 150528
    s_add_u32 s79, s87, 75776
    buffer_load_dwordx4 v13, s[12:15], s79 offen  lds
    s_barrier
    s_add_u32 m0, s97, 65536
    s_add_u32 s79, s88, 2048
    buffer_load_dwordx4 v13, s[12:15], s79 offen  lds
    s_add_u32 m0, s97, 66560
    s_add_u32 s79, s88, 26624
    buffer_load_dwordx4 v13, s[12:15], s79 offen  lds
    s_add_u32 m0, s97, 67584
    s_add_u32 s79, s88, 51200
    buffer_load_dwordx4 v13, s[12:15], s79 offen  lds
    s_add_u32 m0, s97, 68608
    s_add_u32 s79, s88, 75776
    buffer_load_dwordx4 v13, s[12:15], s79 offen  lds
    s_waitcnt vmcnt(12)
    s_barrier
    s_add_u32 m0, s97, 81920
    s_add_u32 s79, s89, 2048
    buffer_load_dwordx4 v13, s[12:15], s79 offen  lds
    s_add_u32 m0, s97, 82944
    s_add_u32 s79, s89, 26624
    buffer_load_dwordx4 v13, s[12:15], s79 offen  lds
    s_add_u32 m0, s97, 83968
    s_add_u32 s79, s89, 51200
    buffer_load_dwordx4 v13, s[12:15], s79 offen  lds
    s_add_u32 m0, s97, 84992
    s_add_u32 s79, s89, 75776
    buffer_load_dwordx4 v13, s[12:15], s79 offen  lds
    s_mov_b32 s28, s64
    s_mov_b32 s29, s65
    s_mov_b32 s30, 39845888
    s_mov_b32 s31, 0x00020000
    s_mov_b32 s16, s48
    s_mov_b32 s17, s49
    s_mov_b32 s18, 524288
    s_mov_b32 s19, 0x00020000
    s_mov_b32 s20, s52
    s_mov_b32 s21, s53
    s_mov_b32 s22, 1409024
    s_mov_b32 s23, 0x00020000
    s_mov_b32 s36, s54
    s_mov_b32 s37, s55
    s_mov_b32 s38, 2752
    s_mov_b32 s39, 0x00020000
    s_mov_b32 s24, s56
    s_mov_b32 s25, s57
    s_mov_b32 s26, 1409024
    s_mov_b32 s27, 0x00020000
    s_mov_b32 s40, s58
    s_mov_b32 s41, s59
    s_mov_b32 s42, 1024
    s_mov_b32 s43, 0x00020000
    s_mov_b32 s32, s60
    s_mov_b32 s33, s61
    s_mov_b32 s34, 2097152
    s_mov_b32 s35, 0x00020000
    s_min_u32 s74, s69, 3
    s_mul_i32 s71, s69, 5
    s_add_u32 s71, s71, s74
    s_cmp_lt_u32 s69, 3
    s_cselect_b32 s92, 6, 5
    s_lshl_b32 s76, s69, 7
    s_lshl_b32 s77, s68, 16
    s_add_u32 s83, s77, s76
    v_lshlrev_b32 v246, 4, v1
    v_lshlrev_b32 v249, 2, v1
    s_and_b32 s72, s3, 2
    s_lshl_b32 s72, s72, 13
    s_waitcnt vmcnt(12)
    s_barrier
    s_add_u32 m0, s97, 98304
    s_add_u32 s79, s86, 0
    buffer_load_dwordx4 v13, s[12:15], s79 offen  lds
    s_add_u32 m0, s97, 99328
    s_add_u32 s79, s86, 24576
    buffer_load_dwordx4 v13, s[12:15], s79 offen  lds
    s_add_u32 m0, s97, 100352
    s_add_u32 s79, s86, 49152
    buffer_load_dwordx4 v13, s[12:15], s79 offen  lds
    s_add_u32 m0, s97, 101376
    s_add_u32 s79, s86, 73728
    buffer_load_dwordx4 v13, s[12:15], s79 offen  lds
    s_and_b32 s73, s3, 1
    s_lshl_b32 s73, s73, 2
    v_and_b32 v10, 31, v1
    v_lshlrev_b32 v10, 8, v10
    v_lshrrev_b32 v11, 5, v1
    v_xor_b32 v11, v11, v1
    v_and_b32 v11, 1, v11
    v_lshl_add_u32 v10, v11, 7, v10
    v_add_u32 v10, s72, v10
    v_and_b32 v11, 7, v1
    v_xor_b32 v11, s73, v11
    v_xor_b32 v240, 0, v11
    v_lshl_add_u32 v240, v240, 4, v10
    v_xor_b32 v241, 1, v11
    v_lshl_add_u32 v241, v241, 4, v10
    v_xor_b32 v242, 2, v11
    v_lshl_add_u32 v242, v242, 4, v10
    v_xor_b32 v243, 3, v11
    v_lshl_add_u32 v243, v243, 4, v10
    v_lshrrev_b32 v10, 3, v0
    v_xor_b32 v11, v10, v0
    v_and_b32 v11, 7, v11
    v_lshlrev_b32 v11, 4, v11
    v_lshl_add_u32 v11, v10, 8, v11
    v_and_b32 v10, 1, v10
    v_lshl_add_u32 v244, v10, 7, v11
    v_xor_b32 v245, 128, v244
    s_and_b32 s72, s3, 3
    s_lshl_b32 s74, s66, 2
    s_add_u32 s74, s74, s72
    s_lshl_b32 s74, s74, 17
    s_add_u32 s74, s74, 1048576
    v_and_b32 v10, 15, v1
    v_lshrrev_b32 v11, 5, v1
    v_lshl_add_u32 v10, v11, 4, v10
    v_lshl_add_u32 v14, v10, 4, s74
    v_add_u32 v15, s74, v246
    s_lshr_b32 s73, s3, 2
    s_mul_i32 s81, s73, 98304
    s_lshl_b32 s62, s67, 12
    s_waitcnt vmcnt(12)
    s_barrier
    s_add_u32 m0, s97, 114688
    s_add_u32 s79, s87, 0
    buffer_load_dwordx4 v13, s[12:15], s79 offen  lds
    s_add_u32 m0, s97, 115712
    s_add_u32 s79, s87, 24576
    buffer_load_dwordx4 v13, s[12:15], s79 offen  lds
    s_add_u32 m0, s97, 116736
    s_add_u32 s79, s87, 49152
    buffer_load_dwordx4 v13, s[12:15], s79 offen  lds
    s_add_u32 m0, s97, 117760
    s_add_u32 s79, s87, 73728
    buffer_load_dwordx4 v13, s[12:15], s79 offen  lds
    s_add_u32 s63, s62, 4096
    s_and_b32 s63, s63, 0x1ffff
    s_and_b32 s74, s62, 0x7fff
    s_cmp_ge_u32 s81, s74
    s_cselect_b32 s75, 4096, 0
    s_add_u32 s81, s81, s75
    s_and_b32 s74, s62, 0x18000
    s_add_u32 s81, s81, s74
    s_and_b32 s81, s81, 0x1ffff
    s_mov_b32 s84, 0xffff
    s_mov_b32 s85, 0xffff
    v_and_b32 v10, 0x1b, v1
    v_cmp_eq_u32 vcc, 16, v10
    v_mov_b32 v10, 0x3f803f80
    v_mov_b32 v11, 0
    v_cndmask_b32 v214, v11, v10, vcc
    s_lshl_b32 s74, s3, 10
    v_add_u32 v215, s74, v246
    s_lshl_b32 s74, s73, 3
    s_add_u32 s74, s74, s66
    s_lshl_b32 s74, s74, 2
    s_add_u32 s74, s74, s72
    s_lshl_b32 s74, s74, 10
    s_and_b32 s75, s74, 0xffffe000
    s_add_u32 s74, s74, s75
    s_add_u32 s82, s74, 6291456
    s_waitcnt vmcnt(12)
    s_barrier
    s_add_u32 m0, s97, 131072
    s_add_u32 s79, s88, 0
    buffer_load_dwordx4 v13, s[12:15], s79 offen  lds
    s_add_u32 m0, s97, 132096
    s_add_u32 s79, s88, 24576
    buffer_load_dwordx4 v13, s[12:15], s79 offen  lds
    s_add_u32 m0, s97, 133120
    s_add_u32 s79, s88, 49152
    buffer_load_dwordx4 v13, s[12:15], s79 offen  lds
    s_add_u32 m0, s97, 134144
    s_add_u32 s79, s88, 73728
    buffer_load_dwordx4 v13, s[12:15], s79 offen  lds
    v_mov_b32 v48, 0
    v_mov_b32 v49, 0
    v_mov_b32 v50, 0
    v_mov_b32 v51, 0
    v_mov_b32 v52, 0
    v_mov_b32 v53, 0
    v_mov_b32 v54, 0
    v_mov_b32 v55, 0
    v_mov_b32 v56, 0
    v_mov_b32 v57, 0
    v_mov_b32 v58, 0
    v_mov_b32 v59, 0
    v_mov_b32 v60, 0
    v_mov_b32 v61, 0
    v_mov_b32 v62, 0
    v_mov_b32 v63, 0
    v_mov_b32 v64, 0
    v_mov_b32 v65, 0
    v_mov_b32 v66, 0
    v_mov_b32 v67, 0
    v_mov_b32 v68, 0
    v_mov_b32 v69, 0
    v_mov_b32 v70, 0
    v_mov_b32 v71, 0
    v_mov_b32 v72, 0
    v_mov_b32 v73, 0
    v_mov_b32 v74, 0
    v_mov_b32 v75, 0
    v_mov_b32 v76, 0
    v_mov_b32 v77, 0
    v_mov_b32 v78, 0
    v_mov_b32 v79, 0
    v_mov_b32 v80, 0
    v_mov_b32 v81, 0
    v_mov_b32 v82, 0
    v_mov_b32 v83, 0
    s_waitcnt vmcnt(12)
    s_barrier
    s_add_u32 m0, s97, 147456
    s_add_u32 s79, s89, 0
    buffer_load_dwordx4 v13, s[12:15], s79 offen  lds
    s_add_u32 m0, s97, 148480
    s_add_u32 s79, s89, 24576
    buffer_load_dwordx4 v13, s[12:15], s79 offen  lds
    s_add_u32 m0, s97, 149504
    s_add_u32 s79, s89, 49152
    buffer_load_dwordx4 v13, s[12:15], s79 offen  lds
    s_add_u32 m0, s97, 150528
    s_add_u32 s79, s89, 73728
    buffer_load_dwordx4 v13, s[12:15], s79 offen  lds
    v_mov_b32 v84, 0
    v_mov_b32 v85, 0
    v_mov_b32 v86, 0
    v_mov_b32 v87, 0
    v_mov_b32 v92, v214
    v_mov_b32 v93, v214
    v_mov_b32 v94, v214
    v_mov_b32 v95, v214
    v_mov_b32 v96, v214
    v_mov_b32 v97, v214
    v_mov_b32 v98, v214
    v_mov_b32 v99, v214
    v_mov_b32 v104, v214
    v_mov_b32 v105, v214
    v_mov_b32 v106, v214
    v_mov_b32 v107, v214
    v_mov_b32 v108, v214
    v_mov_b32 v109, v214
    v_mov_b32 v110, v214
    v_mov_b32 v111, v214
    v_mov_b32 v116, v214
    v_mov_b32 v117, v214
    v_mov_b32 v118, v214
    v_mov_b32 v119, v214
    v_mov_b32 v120, v214
    v_mov_b32 v121, v214
    v_mov_b32 v122, v214
    v_mov_b32 v123, v214
    v_mov_b32 v128, v214
    v_mov_b32 v129, v214
    v_mov_b32 v130, v214
    v_mov_b32 v131, v214
    v_mov_b32 v132, v214
    v_mov_b32 v133, v214
    v_mov_b32 v134, v214
    v_mov_b32 v135, v214
    s_waitcnt vmcnt(12)
    s_barrier
    s_lshl_b32 s76, s69, 7
    v_lshrrev_b32 v10, 3, v1
    v_and_b32 v11, 7, v1
    v_lshlrev_b32 v12, 1, v10
    v_and_b32 v12, 4, v12
    v_xor_b32 v11, v11, v12
    v_mul_u32_u24 v10, 1024, v10
    v_lshl_add_u32 v10, v11, 4, v10
    v_add_u32 v12, s76, v10
    s_lshl_b32 s76, s71, 6
    v_lshrrev_b32 v10, 3, v1
    v_and_b32 v11, 7, v1
    v_lshlrev_b32 v13, 1, v10
    v_and_b32 v13, 4, v13
    v_xor_b32 v11, v11, v13
    v_mul_u32_u24 v10, 2752, v10
    v_lshl_add_u32 v10, v11, 4, v10
    v_add_u32 v13, s76, v10
    v_lshrrev_b32 v10, 2, v1
    v_mul_u32_u24 v10, 2752, v10
    v_and_b32 v11, 3, v1
    v_lshlrev_b32 v11, 7, v11
    v_min_u32 v11, 252, v11
    v_add3_u32 v3, v10, v11, s76
    s_and_b32 s72, s3, 3
    s_lshl_b32 s86, s72, 13
    s_lshl_b32 s87, s72, 10
    s_mul_i32 s88, s72, 22016
    s_and_b32 s76, s68, 3
    s_lshl_b32 s76, s76, 2
    s_add_u32 s76, s76, s72
    s_mul_i32 s96, s76, 88064
    s_and_b32 s74, s3, 1
    s_bfe_u32 s75, s3, 0x10001
    v_bfe_u32 v10, v1, 2, 2
    v_lshrrev_b32 v11, 1, v10
    v_xor_b32 v11, s74, v11
    v_lshlrev_b32 v11, 6, v11
    s_waitcnt vmcnt(8)
    s_barrier
    v_lshl_add_u32 v11, v10, 7, v11
    v_bfe_u32 v10, v1, 4, 1
    v_lshl_add_u32 v11, v10, 5, v11
    v_and_b32 v10, 3, v1
    v_lshl_add_u32 v11, v10, 3, v11
    v_lshrrev_b32 v10, 5, v1
    v_lshl_add_u32 v7, v10, 10, v11
    s_mul_i32 s76, s75, 49152
    s_add_u32 s76, s76, 65536
    v_add_u32 v4, s76, v7
    s_lshl_b32 s79, s74, 10
    s_add_u32 s76, s76, s79
    s_mul_i32 s77, s75, 16384
    s_add_u32 s77, s77, 131072
    v_add_u32 v5, s77, v7
    s_lshl_b32 s79, s74, 10
    s_add_u32 s77, s77, s79
    s_mul_i32 s78, s75, 22528
    s_add_u32 s78, s78, 20480
    v_add_u32 v6, s78, v7
    s_lshl_b32 s79, s74, 10
    s_add_u32 s78, s78, s79
    v_mov_b32 v8, 0xdddddddd
    s_waitcnt vmcnt(4)
    s_barrier
    s_mul_i32 s70, s70, 0x0019660d
    s_add_u32 s70, s70, 0x3c6ef35f
    v_mov_b32 v248, s70
    s_and_b32 s93, s67, 7
    s_lshl_b32 s98, s67, 2
    s_and_b32 s98, s98, 0x60
    s_add_u32 s93, s93, s98
    s_lshl_b32 s98, s66, 9
    s_lshl_b32 s79, s93, 2
    s_add_u32 s98, s98, s79
    s_add_u32 s98, s98, 16384
    s_lshl_b32 s99, s66, 9
    s_add_u32 s99, s99, 16384
    v_and_b32 v10, 7, v1
    v_lshrrev_b32 v11, 3, v1
    v_lshlrev_b32 v11, 7, v11
    v_lshl_add_u32 v216, v10, 2, v11
    s_waitcnt vmcnt(0)
    s_barrier
    buffer_load_dwordx4 v[252:255], v2, s[8:11], s83 offen
    v_and_b32 v10, 0x70, v246
    s_lshl_b32 s79, s69, 7
    buffer_load_dwordx4 v[236:239], v10, s[40:43], s79 offen
    s_barrier
    s_cmp_lg_u32 s3, 4
    s_cbranch_scc1 L_nf_1
    s_mov_b64 exec, 1
    buffer_store_dword v248, v249, s[28:31], s98 offen offset:0 sc1
    s_mov_b64 exec, -1
L_nf_1:
    v_mov_b32 v9, 0
    ds_write_b32 v9, v9 offset:40960
    s_waitcnt lgkmcnt(0)
    s_barrier
    v_xor_b32 v10, 4096, v215
    ds_read_b128 v[20:23], v215 offset:32768
    ds_read_b128 v[16:19], v10 offset:32768
    s_lshr_b32 s79, s67, 3
    s_lshl_b32 s79, s79, 7
    v_add_u32 v10, s79, v249
    s_cmp_lg_u32 s3, 4
    s_cbranch_scc1 L_skip_2
    s_mov_b32 exec_hi, 0
    s_mov_b32 exec_lo, 0xff
    s_mov_b32 s93, 0
L_poll_3:
    buffer_load_dword v247, v10, s[28:31], s99 offen offset:0 sc1
    s_add_u32 s93, s93, 1
    s_waitcnt vmcnt(0)
    v_cmp_eq_u32 vcc, v247, v248
    s_cmp_gt_u32 s93, 200000
    s_cbranch_scc1 L_done_4
    s_cmp_eq_u64 vcc, exec
    s_cbranch_scc0 L_poll_3
L_done_4:
    s_mov_b64 exec, -1
L_skip_2:
    s_waitcnt lgkmcnt(0)
    s_barrier
    s_cmp_lg_u32 s3, 4
    s_cbranch_scc1 L_skip_5
    s_mov_b32 exec_hi, 0
    s_mov_b32 exec_lo, 0xffffffff
    s_mov_b32 s93, 0
L_poll_6:
    buffer_load_dword v247, v216, s[28:31], s99 offen offset:0 sc1
    s_add_u32 s93, s93, 1
    s_waitcnt vmcnt(0)
    v_cmp_eq_u32 vcc, v247, v248
    s_cmp_gt_u32 s93, 200000
    s_cbranch_scc1 L_done_7
    s_cmp_eq_u64 vcc, exec
    s_cbranch_scc0 L_poll_6
L_done_7:
    s_mov_b64 exec, -1
L_skip_5:
    s_cmp_lg_u32 s3, 4
    s_cbranch_scc1 L_w_8
    v_mov_b32 v10, 1
    ds_write_b32 v9, v10 offset:40960
L_w_8:
    s_cmp_lg_u32 s3, 5
    s_cbranch_scc1 L_w_9
    s_cmp_lg_u32 s69, 0
    s_cbranch_scc1 L_nl_10
    s_lshl_b32 s74, s68, 20
    s_add_u32 s74, s74, 6947584
    s_add_u32 s75, s74, 8192
    s_memtime s[44:45]
    s_waitcnt lgkmcnt(0)
    s_load_dword s58, s[64:65], s74 glc
    s_waitcnt lgkmcnt(0)
    s_memtime s[46:47]
    s_waitcnt lgkmcnt(0)
    s_load_dword s58, s[64:65], s75 glc
    s_waitcnt lgkmcnt(0)
    s_memtime s[48:49]
    s_waitcnt lgkmcnt(0)
    s_sub_u32 s44, s46, s44
    s_sub_u32 s46, s48, s46
    s_mov_b32 s74, s44
    s_mov_b32 s75, s46
    s_cmp_lt_u32 s75, s74
    s_cselect_b32 s74, 4, 0
    s_lshl_b32 s79, s68, 6
    s_add_u32 s79, s79, s74
    s_add_u32 s79, s79, 4096
    s_mov_b64 exec, 1
    buffer_store_dword v248, v249, s[28:31], s79 offen sc1
    s_mov_b64 exec, -1
L_nl_10:
L_w_9:
    s_mov_b32 s93, 0
L_go:
    ds_read_b32 v10, v9 offset:40960
    s_add_u32 s93, s93, 1
    s_lshr_b32 s74, s93, 22
    s_waitcnt lgkmcnt(0)
    v_readfirstlane_b32 s79, v10
    s_nop 0
    s_or_b32 s79, s79, s74
    s_cbranch_scc0 L_go
    s_setprio 1
    buffer_load_dwordx4 v[88:91], v15, s[28:31], s81 offen offset:0 sc1
    s_mov_b64 exec, s[84:85]
    buffer_load_dwordx4 v[92:95], v14, s[28:31], s81 offen offset:1024 sc1
    buffer_load_dwordx4 v[96:99], v14, s[28:31], s81 offen offset:1536 sc1
    s_mov_b64 exec, -1
    buffer_load_dwordx4 v[100:103], v15, s[28:31], s81 offen offset:2048 sc1
    s_mov_b64 exec, s[84:85]
    buffer_load_dwordx4 v[104:107], v14, s[28:31], s81 offen offset:3072 sc1
    buffer_load_dwordx4 v[108:111], v14, s[28:31], s81 offen offset:3584 sc1
    s_mov_b64 exec, -1
    s_add_u32 s81, s81, 4096
    s_and_b32 s81, s81, 0x1ffff
    buffer_load_dwordx4 v[112:115], v15, s[28:31], s81 offen offset:0 sc1
    s_mov_b64 exec, s[84:85]
    buffer_load_dwordx4 v[116:119], v14, s[28:31], s81 offen offset:1024 sc1
    buffer_load_dwordx4 v[120:123], v14, s[28:31], s81 offen offset:1536 sc1
    s_mov_b64 exec, -1
    s_waitcnt vmcnt(6) lgkmcnt(0)
    v_mfma_f32_32x32x16_bf16 v[24:39], v[88:91], v[16:19], 0
    s_nop 7
    s_nop 3
    s_lshl_b32 s74, s2, 2
    s_add_u32 s74, s74, s3
    s_sub_u32 s74, s74, 4
    s_lshl_b32 s75, s74, 9
    s_mul_i32 s74, s74, 1408
    v_lshlrev_b32 v10, 7, v1
    s_mov_b64 exec, 0xf
    buffer_load_dword v251, v10, s[16:19], s75 offen
    s_mov_b64 exec, 0x7ff
    buffer_load_dword v251, v10, s[24:27], s74 offen
    s_mov_b64 exec, 0x7ff
    buffer_load_dword v251, v10, s[20:23], s74 offen
    s_mov_b64 exec, -1
    v_exp_f32 v24, v24
    v_exp_f32 v25, v25
    v_smfmac_f32_32x32x32_bf16 v[72:87], v[132:135], v[48:55], v8
    v_exp_f32 v26, v26
    v_exp_f32 v27, v27
    v_exp_f32 v28, v28
    v_mfma_f32_32x32x16_bf16 v[40:55], v[88:91], v[20:23], 0
    v_exp_f32 v29, v29
    v_exp_f32 v30, v30
    v_exp_f32 v31, v31
    v_exp_f32 v32, v32
    v_exp_f32 v33, v33
    v_smfmac_f32_32x32x32_bf16 v[56:71], v[92:95], v[24:31], v8
    v_exp_f32 v34, v34
    v_exp_f32 v35, v35
    buffer_load_dwordx4 v[124:127], v15, s[28:31], s81 offen offset:2048 sc1
    s_mov_b64 exec, s[84:85]
    buffer_load_dwordx4 v[128:131], v14, s[28:31], s81 offen offset:3072 sc1
    buffer_load_dwordx4 v[132:135], v14, s[28:31], s81 offen offset:3584 sc1
    s_mov_b64 exec, -1
    s_add_u32 s81, s81, 4096
    s_and_b32 s81, s81, 0x1ffff
    v_exp_f32 v36, v36
    v_exp_f32 v37, v37
    v_exp_f32 v38, v38
    v_exp_f32 v39, v39
    v_exp_f32 v40, v40
    v_exp_f32 v41, v41
    v_smfmac_f32_32x32x32_bf16 v[56:71], v[96:99], v[32:39], v8
    v_exp_f32 v42, v42
    v_exp_f32 v43, v43
    v_exp_f32 v44, v44
    s_waitcnt vmcnt(9)
    v_mfma_f32_32x32x16_bf16 v[24:39], v[100:103], v[16:19], 0
    v_exp_f32 v45, v45
    v_exp_f32 v46, v46
    v_exp_f32 v47, v47
    v_exp_f32 v48, v48
    v_exp_f32 v49, v49
    v_smfmac_f32_32x32x32_bf16 v[72:87], v[92:95], v[40:47], v8
    v_exp_f32 v50, v50
    v_exp_f32 v51, v51
    v_exp_f32 v52, v52
    s_lshr_b32 s74, s2, 3
    s_lshl_b32 s74, s74, 2
    s_add_u32 s74, s74, s72
    s_lshl_b32 s75, s74, 12
    s_mul_i32 s74, s74, 11264
    v_lshlrev_b32 v10, 10, v1
    s_mov_b64 exec, 0xf
    buffer_load_dword v251, v10, s[16:19], s75 offen offset:384
    s_mov_b64 exec, 0x7ff
    buffer_load_dword v251, v10, s[24:27], s74 offen offset:384
    s_mov_b64 exec, -1
    v_exp_f32 v53, v53
    v_exp_f32 v54, v54
    v_exp_f32 v55, v55
    s_barrier
    v_exp_f32 v24, v24
    v_exp_f32 v25, v25
    v_smfmac_f32_32x32x32_bf16 v[72:87], v[96:99], v[48:55], v8
    v_exp_f32 v26, v26
    v_exp_f32 v27, v27
    v_exp_f32 v28, v28
    v_mfma_f32_32x32x16_bf16 v[40:55], v[100:103], v[20:23], 0
    v_exp_f32 v29, v29
    v_exp_f32 v30, v30
    v_exp_f32 v31, v31
    v_exp_f32 v32, v32
    v_exp_f32 v33, v33
    v_smfmac_f32_32x32x32_bf16 v[56:71], v[104:107], v[24:31], v8
    v_exp_f32 v34, v34
    v_exp_f32 v35, v35
    buffer_load_dwordx4 v[88:91], v15, s[28:31], s81 offen offset:0 sc1
    s_mov_b64 exec, s[84:85]
    buffer_load_dwordx4 v[92:95], v14, s[28:31], s81 offen offset:1024 sc1
    buffer_load_dwordx4 v[96:99], v14, s[28:31], s81 offen offset:1536 sc1
    s_mov_b64 exec, -1
    v_exp_f32 v36, v36
    s_add_u32 m0, s87, 0
    s_add_u32 s79, s86, 0
    buffer_load_dwordx4 v12, s[16:19], s79 offen  lds
    s_add_u32 m0, s87, 4096
    s_add_u32 s79, s86, 32768
    buffer_load_dwordx4 v12, s[16:19], s79 offen  lds
    s_add_u32 m0, s87, 8192
    s_add_u32 s79, s86, 65536
    buffer_load_dwordx4 v12, s[16:19], s79 offen  lds
    s_add_u32 m0, s87, 12288
    s_add_u32 s79, s86, 98304
    buffer_load_dwordx4 v12, s[16:19], s79 offen  lds
    s_add_u32 m0, s87, 16384
    s_add_u32 s79, s86, 131072
    buffer_load_dwordx4 v12, s[16:19], s79 offen  lds
    v_exp_f32 v37, v37
    v_exp_f32 v38, v38
    v_exp_f32 v39, v39
    v_exp_f32 v40, v40
    v_exp_f32 v41, v41
    v_smfmac_f32_32x32x32_bf16 v[56:71], v[108:111], v[32:39], v8
    v_exp_f32 v42, v42
    v_exp_f32 v43, v43
    v_exp_f32 v44, v44
    s_waitcnt vmcnt(16)
    v_mfma_f32_32x32x16_bf16 v[24:39], v[112:115], v[16:19], 0
    v_exp_f32 v45, v45
    v_exp_f32 v46, v46
    v_exp_f32 v47, v47
    v_exp_f32 v48, v48
    v_exp_f32 v49, v49
    v_smfmac_f32_32x32x32_bf16 v[72:87], v[104:107], v[40:47], v8
    v_exp_f32 v50, v50
    v_exp_f32 v51, v51
    v_exp_f32 v52, v52
    s_add_u32 m0, s87, 20480
    s_add_u32 s79, s86, 163840
    buffer_load_dwordx4 v12, s[16:19], s79 offen  lds
    s_add_u32 m0, s87, 24576
    s_add_u32 s79, s86, 196608
    buffer_load_dwordx4 v12, s[16:19], s79 offen  lds
    s_add_u32 m0, s87, 28672
    s_add_u32 s79, s86, 229376
    buffer_load_dwordx4 v12, s[16:19], s79 offen  lds
    s_add_u32 m0, s87, 32768
    s_add_u32 s79, s86, 262144
    buffer_load_dwordx4 v12, s[16:19], s79 offen  lds
    s_add_u32 m0, s87, 36864
    s_add_u32 s79, s86, 294912
    buffer_load_dwordx4 v12, s[16:19], s79 offen  lds
    v_exp_f32 v53, v53
    v_exp_f32 v54, v54
    v_exp_f32 v55, v55
    v_exp_f32 v24, v24
    v_exp_f32 v25, v25
    v_smfmac_f32_32x32x32_bf16 v[72:87], v[108:111], v[48:55], v8
    v_exp_f32 v26, v26
    v_exp_f32 v27, v27
    v_exp_f32 v28, v28
    v_mfma_f32_32x32x16_bf16 v[40:55], v[112:115], v[20:23], 0
    v_exp_f32 v29, v29
    v_exp_f32 v30, v30
    v_exp_f32 v31, v31
    v_exp_f32 v32, v32
    v_exp_f32 v33, v33
    v_smfmac_f32_32x32x32_bf16 v[56:71], v[116:119], v[24:31], v8
    v_exp_f32 v34, v34
    v_exp_f32 v35, v35
    buffer_load_dwordx4 v[100:103], v15, s[28:31], s81 offen offset:2048 sc1
    s_mov_b64 exec, s[84:85]
    buffer_load_dwordx4 v[104:107], v14, s[28:31], s81 offen offset:3072 sc1
    buffer_load_dwordx4 v[108:111], v14, s[28:31], s81 offen offset:3584 sc1
    s_mov_b64 exec, -1
    s_add_u32 s81, s81, 4096
    s_and_b32 s81, s81, 0x1ffff
    v_exp_f32 v36, v36
    s_add_u32 m0, s87, 40960
    s_add_u32 s79, s86, 327680
    buffer_load_dwordx4 v12, s[16:19], s79 offen  lds
    s_add_u32 m0, s87, 45056
    s_add_u32 s79, s86, 360448
    buffer_load_dwordx4 v12, s[16:19], s79 offen  lds
    s_add_u32 m0, s87, 49152
    s_add_u32 s79, s86, 393216
    buffer_load_dwordx4 v12, s[16:19], s79 offen  lds
    s_add_u32 m0, s87, 53248
    s_add_u32 s79, s86, 425984
    buffer_load_dwordx4 v12, s[16:19], s79 offen  lds
    s_add_u32 m0, s87, 57344
    s_add_u32 s79, s86, 458752
    buffer_load_dwordx4 v12, s[16:19], s79 offen  lds
    v_exp_f32 v37, v37
    v_exp_f32 v38, v38
    v_exp_f32 v39, v39
    v_exp_f32 v40, v40
    v_exp_f32 v41, v41
    v_smfmac_f32_32x32x32_bf16 v[56:71], v[120:123], v[32:39], v8
    v_exp_f32 v42, v42
    v_exp_f32 v43, v43
    v_exp_f32 v44, v44
    s_waitcnt vmcnt(23)
    v_mfma_f32_32x32x16_bf16 v[24:39], v[124:127], v[16:19], 0
    v_exp_f32 v45, v45
    v_exp_f32 v46, v46
    v_exp_f32 v47, v47
    v_exp_f32 v48, v48
    v_exp_f32 v49, v49
    v_smfmac_f32_32x32x32_bf16 v[72:87], v[116:119], v[40:47], v8
    v_exp_f32 v50, v50
    v_exp_f32 v51, v51
    v_exp_f32 v52, v52
    s_add_u32 m0, s87, 61440
    s_add_u32 s79, s86, 491520
    buffer_load_dwordx4 v12, s[16:19], s79 offen  lds
    s_add_u32 m0, s76, 0
    s_add_u32 s79, s86, 0
    buffer_load_dwordx4 v12, s[24:27], s79 offen  lds
    s_add_u32 m0, s76, 2048
    s_add_u32 s79, s86, 32768
    buffer_load_dwordx4 v12, s[24:27], s79 offen  lds
    s_add_u32 m0, s76, 4096
    s_add_u32 s79, s86, 196608
    buffer_load_dwordx4 v12, s[24:27], s79 offen  lds
    s_add_u32 m0, s76, 6144
    s_add_u32 s79, s86, 229376
    buffer_load_dwordx4 v12, s[24:27], s79 offen  lds
    v_exp_f32 v53, v53
    v_exp_f32 v54, v54
    v_exp_f32 v55, v55
    v_exp_f32 v24, v24
    v_exp_f32 v25, v25
    v_smfmac_f32_32x32x32_bf16 v[72:87], v[120:123], v[48:55], v8
    v_exp_f32 v26, v26
    v_exp_f32 v27, v27
    v_exp_f32 v28, v28
    v_mfma_f32_32x32x16_bf16 v[40:55], v[124:127], v[20:23], 0
    v_exp_f32 v29, v29
    v_exp_f32 v30, v30
    v_exp_f32 v31, v31
    v_exp_f32 v32, v32
    v_exp_f32 v33, v33
    v_smfmac_f32_32x32x32_bf16 v[56:71], v[128:131], v[24:31], v8
    v_exp_f32 v34, v34
    v_exp_f32 v35, v35
    buffer_load_dwordx4 v[112:115], v15, s[28:31], s81 offen offset:0 sc1
    s_mov_b64 exec, s[84:85]
    buffer_load_dwordx4 v[116:119], v14, s[28:31], s81 offen offset:1024 sc1
    buffer_load_dwordx4 v[120:123], v14, s[28:31], s81 offen offset:1536 sc1
    s_mov_b64 exec, -1
    v_exp_f32 v36, v36
    s_add_u32 m0, s76, 8192
    s_add_u32 s79, s86, 393216
    buffer_load_dwordx4 v12, s[24:27], s79 offen  lds
    s_add_u32 m0, s76, 10240
    s_add_u32 s79, s86, 425984
    buffer_load_dwordx4 v12, s[24:27], s79 offen  lds
    s_add_u32 m0, s76, 12288
    s_add_u32 s79, s86, 589824
    buffer_load_dwordx4 v12, s[24:27], s79 offen  lds
    s_add_u32 m0, s76, 14336
    s_add_u32 s79, s86, 622592
    buffer_load_dwordx4 v12, s[24:27], s79 offen  lds
    s_add_u32 m0, s76, 16384
    s_add_u32 s79, s86, 753664
    buffer_load_dwordx4 v12, s[24:27], s79 offen  lds
    v_exp_f32 v37, v37
    v_exp_f32 v38, v38
    v_exp_f32 v39, v39
    v_exp_f32 v40, v40
    v_exp_f32 v41, v41
    v_smfmac_f32_32x32x32_bf16 v[56:71], v[132:135], v[32:39], v8
    v_exp_f32 v42, v42
    v_exp_f32 v43, v43
    v_exp_f32 v44, v44
    s_waitcnt vmcnt(31)
    v_mfma_f32_32x32x16_bf16 v[24:39], v[88:91], v[16:19], 0
    v_exp_f32 v45, v45
    v_exp_f32 v46, v46
    v_exp_f32 v47, v47
    v_exp_f32 v48, v48
    v_exp_f32 v49, v49
    v_smfmac_f32_32x32x32_bf16 v[72:87], v[128:131], v[40:47], v8
    v_exp_f32 v50, v50
    v_exp_f32 v51, v51
    v_exp_f32 v52, v52
    s_add_u32 m0, s76, 18432
    s_add_u32 s79, s86, 786432
    buffer_load_dwordx4 v12, s[24:27], s79 offen  lds
    s_add_u32 m0, s76, 20480
    s_add_u32 s79, s86, 917504
    buffer_load_dwordx4 v12, s[24:27], s79 offen  lds
    s_add_u32 m0, s76, 22528
    s_add_u32 s79, s86, 950272
    buffer_load_dwordx4 v12, s[24:27], s79 offen  lds
    s_add_u32 m0, s76, 24576
    s_add_u32 s79, s86, 1081344
    buffer_load_dwordx4 v12, s[24:27], s79 offen  lds
    s_add_u32 m0, s76, 26624
    s_add_u32 s79, s86, 1114112
    buffer_load_dwordx4 v12, s[24:27], s79 offen  lds
    v_exp_f32 v53, v53
    v_exp_f32 v54, v54
    v_exp_f32 v55, v55
    v_exp_f32 v24, v24
    v_exp_f32 v25, v25
    v_smfmac_f32_32x32x32_bf16 v[72:87], v[132:135], v[48:55], v8
    v_exp_f32 v26, v26
    v_exp_f32 v27, v27
    v_exp_f32 v28, v28
    v_mfma_f32_32x32x16_bf16 v[40:55], v[88:91], v[20:23], 0
    v_exp_f32 v29, v29
    v_exp_f32 v30, v30
    v_exp_f32 v31, v31
    v_exp_f32 v32, v32
    v_exp_f32 v33, v33
    v_smfmac_f32_32x32x32_bf16 v[56:71], v[92:95], v[24:31], v8
    v_exp_f32 v34, v34
    v_exp_f32 v35, v35
    buffer_load_dwordx4 v[124:127], v15, s[28:31], s81 offen offset:2048 sc1
    s_mov_b64 exec, s[84:85]
    buffer_load_dwordx4 v[128:131], v14, s[28:31], s81 offen offset:3072 sc1
    buffer_load_dwordx4 v[132:135], v14, s[28:31], s81 offen offset:3584 sc1
    s_mov_b64 exec, -1
    s_add_u32 s81, s81, 4096
    s_and_b32 s81, s81, 0x1ffff
    v_exp_f32 v36, v36
    s_add_u32 m0, s76, 28672
    s_add_u32 s79, s86, 1245184
    buffer_load_dwordx4 v12, s[24:27], s79 offen  lds
    s_add_u32 m0, s76, 30720
    s_add_u32 s79, s86, 1277952
    buffer_load_dwordx4 v12, s[24:27], s79 offen  lds
    s_add_u32 m0, s76, 32768
    s_add_u32 s79, s86, 65536
    buffer_load_dwordx4 v12, s[24:27], s79 offen  lds
    s_add_u32 m0, s76, 34816
    s_add_u32 s79, s86, 98304
    buffer_load_dwordx4 v12, s[24:27], s79 offen  lds
    s_add_u32 m0, s76, 36864
    s_add_u32 s79, s86, 262144
    buffer_load_dwordx4 v12, s[24:27], s79 offen  lds
    v_exp_f32 v37, v37
    v_exp_f32 v38, v38
    v_exp_f32 v39, v39
    v_exp_f32 v40, v40
    v_exp_f32 v41, v41
    v_smfmac_f32_32x32x32_bf16 v[56:71], v[96:99], v[32:39], v8
    v_exp_f32 v42, v42
    v_exp_f32 v43, v43
    v_exp_f32 v44, v44
    s_waitcnt vmcnt(31)
    v_mfma_f32_32x32x16_bf16 v[24:39], v[100:103], v[16:19], 0
    v_exp_f32 v45, v45
    v_exp_f32 v46, v46
    v_exp_f32 v47, v47
    v_exp_f32 v48, v48
    v_exp_f32 v49, v49
    v_smfmac_f32_32x32x32_bf16 v[72:87], v[92:95], v[40:47], v8
    v_exp_f32 v50, v50
    v_exp_f32 v51, v51
    v_exp_f32 v52, v52
    s_add_u32 m0, s76, 38912
    s_add_u32 s79, s86, 294912
    buffer_load_dwordx4 v12, s[24:27], s79 offen  lds
    s_add_u32 m0, s76, 40960
    s_add_u32 s79, s86, 458752
    buffer_load_dwordx4 v12, s[24:27], s79 offen  lds
    s_add_u32 m0, s76, 43008
    s_add_u32 s79, s86, 491520
    buffer_load_dwordx4 v12, s[24:27], s79 offen  lds
    s_add_u32 m0, s76, 45056
    s_add_u32 s79, s86, 655360
    buffer_load_dwordx4 v12, s[24:27], s79 offen  lds
    s_add_u32 m0, s76, 47104
    s_add_u32 s79, s86, 688128
    buffer_load_dwordx4 v12, s[24:27], s79 offen  lds
    v_exp_f32 v53, v53
    v_exp_f32 v54, v54
    v_exp_f32 v55, v55
    v_exp_f32 v24, v24
    v_exp_f32 v25, v25
    v_smfmac_f32_32x32x32_bf16 v[72:87], v[96:99], v[48:55], v8
    v_exp_f32 v26, v26
    v_exp_f32 v27, v27
    v_exp_f32 v28, v28
    v_mfma_f32_32x32x16_bf16 v[40:55], v[100:103], v[20:23], 0
    v_exp_f32 v29, v29
    v_exp_f32 v30, v30
    v_exp_f32 v31, v31
    v_exp_f32 v32, v32
    v_exp_f32 v33, v33
    v_smfmac_f32_32x32x32_bf16 v[56:71], v[104:107], v[24:31], v8
    v_exp_f32 v34, v34
    v_exp_f32 v35, v35
    buffer_load_dwordx4 v[88:91], v15, s[28:31], s81 offen offset:0 sc1
    s_mov_b64 exec, s[84:85]
    buffer_load_dwordx4 v[92:95], v14, s[28:31], s81 offen offset:1024 sc1
    buffer_load_dwordx4 v[96:99], v14, s[28:31], s81 offen offset:1536 sc1
    s_mov_b64 exec, -1
    v_exp_f32 v36, v36
    v_exp_f32 v37, v37
    v_exp_f32 v38, v38
    v_exp_f32 v39, v39
    v_exp_f32 v40, v40
    v_exp_f32 v41, v41
    v_smfmac_f32_32x32x32_bf16 v[56:71], v[108:111], v[32:39], v8
    v_exp_f32 v42, v42
    v_exp_f32 v43, v43
    v_exp_f32 v44, v44
    s_waitcnt vmcnt(26)
    v_mfma_f32_32x32x16_bf16 v[24:39], v[112:115], v[16:19], 0
    v_exp_f32 v45, v45
    v_exp_f32 v46, v46
    v_exp_f32 v47, v47
    v_exp_f32 v48, v48
    v_exp_f32 v49, v49
    v_smfmac_f32_32x32x32_bf16 v[72:87], v[104:107], v[40:47], v8
    v_exp_f32 v50, v50
    v_exp_f32 v51, v51
    v_exp_f32 v52, v52
    s_add_u32 s79, s96, 128
    buffer_load_dword v251, v3, s[20:23], s79 offen
    v_exp_f32 v53, v53
    v_exp_f32 v54, v54
    v_exp_f32 v55, v55
    s_waitcnt vmcnt(4)
    s_barrier
    s_lshl_b32 s60, s68, 6
    s_add_u32 s60, s60, 4096
    s_lshl_b32 s61, s67, 6
    s_add_u32 s61, s61, 4096
    s_mov_b32 s93, 0
    s_load_dwordx2 s[56:57], s[64:65], s60
    s_load_dwordx2 s[58:59], s[64:65], s61
    v_exp_f32 v24, v24
    v_exp_f32 v25, v25
    v_smfmac_f32_32x32x32_bf16 v[72:87], v[108:111], v[48:55], v8
    v_exp_f32 v26, v26
    v_exp_f32 v27, v27
    v_exp_f32 v28, v28
    v_mfma_f32_32x32x16_bf16 v[40:55], v[112:115], v[20:23], 0
    v_exp_f32 v29, v29
    v_exp_f32 v30, v30
    v_exp_f32 v31, v31
    v_exp_f32 v32, v32
    v_exp_f32 v33, v33
    v_smfmac_f32_32x32x32_bf16 v[56:71], v[116:119], v[24:31], v8
    v_exp_f32 v34, v34
    v_exp_f32 v35, v35
    buffer_load_dwordx4 v[100:103], v15, s[28:31], s81 offen offset:2048 sc1
    s_mov_b64 exec, s[84:85]
    buffer_load_dwordx4 v[104:107], v14, s[28:31], s81 offen offset:3072 sc1
    buffer_load_dwordx4 v[108:111], v14, s[28:31], s81 offen offset:3584 sc1
    s_mov_b64 exec, -1
    s_add_u32 s81, s81, 4096
    s_and_b32 s81, s81, 0x1ffff
    v_exp_f32 v36, v36
    v_exp_f32 v37, v37
    v_exp_f32 v38, v38
    v_exp_f32 v39, v39
    v_exp_f32 v40, v40
    v_exp_f32 v41, v41
    v_smfmac_f32_32x32x32_bf16 v[56:71], v[120:123], v[32:39], v8
    v_exp_f32 v42, v42
    v_exp_f32 v43, v43
    v_exp_f32 v44, v44
    v_mfma_f32_32x32x16_bf16 v[24:39], v[124:127], v[16:19], 0
    v_exp_f32 v45, v45
    v_exp_f32 v46, v46
    v_exp_f32 v47, v47
    v_exp_f32 v48, v48
    v_exp_f32 v49, v49
    v_smfmac_f32_32x32x32_bf16 v[72:87], v[116:119], v[40:47], v8
    v_exp_f32 v50, v50
    v_exp_f32 v51, v51
    v_exp_f32 v52, v52
    v_exp_f32 v53, v53
    v_exp_f32 v54, v54
    ds_read_b64_tr_b16 v[140:141], v4 offset:0
    ds_read_b64_tr_b16 v[142:143], v4 offset:512
    ds_read_b64_tr_b16 v[144:145], v4 offset:2048
    ds_read_b64_tr_b16 v[146:147], v4 offset:2560
    ds_read_b64_tr_b16 v[148:149], v4 offset:4096
    ds_read_b64_tr_b16 v[150:151], v4 offset:4608
    ds_read_b64_tr_b16 v[152:153], v4 offset:6144
    ds_read_b64_tr_b16 v[154:155], v4 offset:6656
    ds_read_b64_tr_b16 v[156:157], v4 offset:8192
    ds_read_b64_tr_b16 v[158:159], v4 offset:8704
    ds_read_b64_tr_b16 v[160:161], v4 offset:10240
    ds_read_b64_tr_b16 v[162:163], v4 offset:10752
    ds_read_b64_tr_b16 v[164:165], v4 offset:12288
    ds_read_b64_tr_b16 v[166:167], v4 offset:12800
    ds_read_b64_tr_b16 v[168:169], v4 offset:14336
    ds_read_b64_tr_b16 v[170:171], v4 offset:14848
    ds_read_b64_tr_b16 v[172:173], v4 offset:16384
    ds_read_b64_tr_b16 v[174:175], v4 offset:16896
    ds_read_b64_tr_b16 v[176:177], v4 offset:18432
    ds_read_b64_tr_b16 v[178:179], v4 offset:18944
    ds_read_b64_tr_b16 v[180:181], v4 offset:20480
    ds_read_b64_tr_b16 v[182:183], v4 offset:20992
    ds_read_b64_tr_b16 v[184:185], v4 offset:22528
    ds_read_b64_tr_b16 v[186:187], v4 offset:23040
    v_exp_f32 v55, v55
    v_exp_f32 v24, v24
    v_exp_f32 v25, v25
    v_smfmac_f32_32x32x32_bf16 v[72:87], v[120:123], v[48:55], v8
    v_exp_f32 v26, v26
    v_exp_f32 v27, v27
    v_exp_f32 v28, v28
    v_mfma_f32_32x32x16_bf16 v[40:55], v[124:127], v[20:23], 0
    v_exp_f32 v29, v29
    v_exp_f32 v30, v30
    v_exp_f32 v31, v31
    v_exp_f32 v32, v32
    v_exp_f32 v33, v33
    v_smfmac_f32_32x32x32_bf16 v[56:71], v[128:131], v[24:31], v8
    v_exp_f32 v34, v34
    v_exp_f32 v35, v35
    buffer_load_dwordx4 v[112:115], v15, s[28:31], s81 offen offset:0 sc1
    s_mov_b64 exec, s[84:85]
    buffer_load_dwordx4 v[116:119], v14, s[28:31], s81 offen offset:1024 sc1
    buffer_load_dwordx4 v[120:123], v14, s[28:31], s81 offen offset:1536 sc1
    s_mov_b64 exec, -1
    v_exp_f32 v36, v36
    ds_read_b64_tr_b16 v[188:189], v4 offset:24576
    ds_read_b64_tr_b16 v[190:191], v4 offset:25088
    ds_read_b64_tr_b16 v[192:193], v4 offset:26624
    ds_read_b64_tr_b16 v[194:195], v4 offset:27136
    ds_read_b64_tr_b16 v[196:197], v4 offset:28672
    ds_read_b64_tr_b16 v[198:199], v4 offset:29184
    ds_read_b64_tr_b16 v[200:201], v4 offset:30720
    ds_read_b64_tr_b16 v[202:203], v4 offset:31232
    ds_read_b64_tr_b16 v[204:205], v4 offset:32768
    ds_read_b64_tr_b16 v[206:207], v4 offset:33280
    ds_read_b64_tr_b16 v[208:209], v4 offset:34816
    ds_read_b64_tr_b16 v[210:211], v4 offset:35328
    v_exp_f32 v37, v37
    v_exp_f32 v38, v38
    v_exp_f32 v39, v39
    v_exp_f32 v40, v40
    v_exp_f32 v41, v41
    v_smfmac_f32_32x32x32_bf16 v[56:71], v[132:135], v[32:39], v8
    v_exp_f32 v42, v42
    v_exp_f32 v43, v43
    v_exp_f32 v44, v44
    s_waitcnt vmcnt(7)
    v_mfma_f32_32x32x16_bf16 v[24:39], v[88:91], v[16:19], 0
    v_exp_f32 v45, v45
    v_exp_f32 v46, v46
    v_exp_f32 v47, v47
    v_exp_f32 v48, v48
    v_exp_f32 v49, v49
    v_smfmac_f32_32x32x32_bf16 v[72:87], v[128:131], v[40:47], v8
    v_exp_f32 v50, v50
    v_exp_f32 v51, v51
    v_exp_f32 v52, v52
    ds_read_b64_tr_b16 v[212:213], v4 offset:36864
    ds_read_b64_tr_b16 v[214:215], v4 offset:37376
    ds_read_b64_tr_b16 v[216:217], v4 offset:38912
    ds_read_b64_tr_b16 v[218:219], v4 offset:39424
    ds_read_b64_tr_b16 v[220:221], v4 offset:40960
    ds_read_b64_tr_b16 v[222:223], v4 offset:41472
    ds_read_b64_tr_b16 v[224:225], v4 offset:43008
    ds_read_b64_tr_b16 v[226:227], v4 offset:43520
    ds_read_b64_tr_b16 v[228:229], v4 offset:45056
    ds_read_b64_tr_b16 v[230:231], v4 offset:45568
    ds_read_b64_tr_b16 v[232:233], v4 offset:47104
    ds_read_b64_tr_b16 v[234:235], v4 offset:47616
    v_exp_f32 v53, v53
    v_exp_f32 v54, v54
    v_exp_f32 v55, v55
    s_waitcnt lgkmcnt(0)
    s_barrier
L_hp_11:
    s_waitcnt lgkmcnt(0)
    s_cmp_eq_u32 s56, s70
    s_cselect_b32 s56, 8192, 0
    s_cmp_eq_u32 s57, s70
    s_cselect_b32 s57, 8192, 0
    s_cmp_eq_u32 s58, s70
    s_cselect_b32 s58, 8192, 0
    s_cmp_eq_u32 s59, s70
    s_cselect_b32 s59, 8192, 0
    s_or_b32 s56, s56, s57
    s_or_b32 s58, s58, s59
    s_and_b32 s56, s56, s58
    s_cbranch_scc1 L_hok_12
    s_add_u32 s93, s93, 1
    s_cmp_gt_u32 s93, 200000
    s_cbranch_scc1 L_hok_12
    s_load_dwordx2 s[56:57], s[64:65], s60 glc
    s_load_dwordx2 s[58:59], s[64:65], s61 glc
    s_branch L_hp_11
L_hok_12:
    s_lshl_b32 s60, s68, 20
    s_add_u32 s60, s60, s57
    s_lshl_b32 s61, s67, 20
    s_add_u32 s61, s61, s59
    s_add_u32 s82, s82, s61
    v_exp_f32 v24, v24
    v_exp_f32 v25, v25
    v_smfmac_f32_32x32x32_bf16 v[72:87], v[132:135], v[48:55], v8
    v_exp_f32 v26, v26
    v_exp_f32 v27, v27
    v_exp_f32 v28, v28
    v_mfma_f32_32x32x16_bf16 v[40:55], v[88:91], v[20:23], 0
    v_exp_f32 v29, v29
    v_exp_f32 v30, v30
    v_exp_f32 v31, v31
    v_exp_f32 v32, v32
    v_exp_f32 v33, v33
    v_smfmac_f32_32x32x32_bf16 v[56:71], v[92:95], v[24:31], v8
    v_exp_f32 v34, v34
    v_exp_f32 v35, v35
    buffer_load_dwordx4 v[124:127], v15, s[28:31], s81 offen offset:2048 sc1
    s_mov_b64 exec, s[84:85]
    buffer_load_dwordx4 v[128:131], v14, s[28:31], s81 offen offset:3072 sc1
    buffer_load_dwordx4 v[132:135], v14, s[28:31], s81 offen offset:3584 sc1
    s_mov_b64 exec, -1
    s_add_u32 s81, s81, 4096
    s_and_b32 s81, s81, 0x1ffff
    v_exp_f32 v36, v36
    s_add_u32 m0, s77, 0
    s_add_u32 s79, s86, 819200
    buffer_load_dwordx4 v12, s[24:27], s79 offen  lds
    s_add_u32 m0, s77, 2048
    s_add_u32 s79, s86, 851968
    buffer_load_dwordx4 v12, s[24:27], s79 offen  lds
    s_add_u32 m0, s77, 4096
    s_add_u32 s79, s86, 983040
    buffer_load_dwordx4 v12, s[24:27], s79 offen  lds
    s_add_u32 m0, s77, 6144
    s_add_u32 s79, s86, 1015808
    buffer_load_dwordx4 v12, s[24:27], s79 offen  lds
    v_exp_f32 v37, v37
    v_exp_f32 v38, v38
    v_exp_f32 v39, v39
    v_exp_f32 v40, v40
    v_exp_f32 v41, v41
    v_smfmac_f32_32x32x32_bf16 v[56:71], v[96:99], v[32:39], v8
    v_exp_f32 v42, v42
    v_exp_f32 v43, v43
    v_exp_f32 v44, v44
    s_waitcnt vmcnt(10)
    v_mfma_f32_32x32x16_bf16 v[24:39], v[100:103], v[16:19], 0
    v_exp_f32 v45, v45
    v_exp_f32 v46, v46
    v_exp_f32 v47, v47
    v_exp_f32 v48, v48
    v_exp_f32 v49, v49
    v_smfmac_f32_32x32x32_bf16 v[72:87], v[92:95], v[40:47], v8
    v_exp_f32 v50, v50
    v_exp_f32 v51, v51
    v_exp_f32 v52, v52
    s_add_u32 m0, s77, 8192
    s_add_u32 s79, s86, 1146880
    buffer_load_dwordx4 v12, s[24:27], s79 offen  lds
    s_add_u32 m0, s77, 10240
    s_add_u32 s79, s86, 1179648
    buffer_load_dwordx4 v12, s[24:27], s79 offen  lds
    s_add_u32 m0, s77, 12288
    s_add_u32 s79, s86, 1310720
    buffer_load_dwordx4 v12, s[24:27], s79 offen  lds
    s_add_u32 m0, s77, 14336
    s_add_u32 s79, s86, 1343488
    buffer_load_dwordx4 v12, s[24:27], s79 offen  lds
    v_exp_f32 v53, v53
    v_exp_f32 v54, v54
    v_exp_f32 v55, v55
    v_exp_f32 v24, v24
    v_exp_f32 v25, v25
    v_smfmac_f32_32x32x32_bf16 v[72:87], v[96:99], v[48:55], v8
    v_exp_f32 v26, v26
    v_exp_f32 v27, v27
    v_exp_f32 v28, v28
    v_mfma_f32_32x32x16_bf16 v[40:55], v[100:103], v[20:23], 0
    v_exp_f32 v29, v29
    v_exp_f32 v30, v30
    v_exp_f32 v31, v31
    v_exp_f32 v32, v32
    v_exp_f32 v33, v33
    v_smfmac_f32_32x32x32_bf16 v[56:71], v[104:107], v[24:31], v8
    v_exp_f32 v34, v34
    v_exp_f32 v35, v35
    buffer_load_dwordx4 v[88:91], v15, s[28:31], s81 offen offset:0 sc1
    s_mov_b64 exec, s[84:85]
    buffer_load_dwordx4 v[92:95], v14, s[28:31], s81 offen offset:1024 sc1
    buffer_load_dwordx4 v[96:99], v14, s[28:31], s81 offen offset:1536 sc1
    s_mov_b64 exec, -1
    v_exp_f32 v36, v36
    s_add_u32 m0, s78, 0
    s_add_u32 s79, s86, 131072
    buffer_load_dwordx4 v12, s[24:27], s79 offen  lds
    s_add_u32 m0, s78, 2048
    s_add_u32 s79, s86, 163840
    buffer_load_dwordx4 v12, s[24:27], s79 offen  lds
    s_add_u32 m0, s78, 4096
    s_add_u32 s79, s86, 327680
    buffer_load_dwordx4 v12, s[24:27], s79 offen  lds
    s_add_u32 m0, s78, 6144
    s_add_u32 s79, s86, 360448
    buffer_load_dwordx4 v12, s[24:27], s79 offen  lds
    s_add_u32 m0, s78, 8192
    s_add_u32 s79, s86, 524288
    buffer_load_dwordx4 v12, s[24:27], s79 offen  lds
    v_exp_f32 v37, v37
    v_exp_f32 v38, v38
    v_exp_f32 v39, v39
    v_exp_f32 v40, v40
    v_exp_f32 v41, v41
    v_smfmac_f32_32x32x32_bf16 v[56:71], v[108:111], v[32:39], v8
    v_exp_f32 v42, v42
    v_exp_f32 v43, v43
    v_exp_f32 v44, v44
    s_waitcnt vmcnt(19)
    v_mfma_f32_32x32x16_bf16 v[24:39], v[112:115], v[16:19], 0
    v_exp_f32 v45, v45
    v_exp_f32 v46, v46
    v_exp_f32 v47, v47
    v_exp_f32 v48, v48
    v_exp_f32 v49, v49
    v_smfmac_f32_32x32x32_bf16 v[72:87], v[104:107], v[40:47], v8
    v_exp_f32 v50, v50
    v_exp_f32 v51, v51
    v_exp_f32 v52, v52
    s_add_u32 m0, s78, 10240
    s_add_u32 s79, s86, 557056
    buffer_load_dwordx4 v12, s[24:27], s79 offen  lds
    s_add_u32 m0, s78, 12288
    s_add_u32 s79, s86, 720896
    buffer_load_dwordx4 v12, s[24:27], s79 offen  lds
    s_add_u32 m0, s78, 14336
    s_add_u32 s79, s86, 884736
    buffer_load_dwordx4 v12, s[24:27], s79 offen  lds
    s_add_u32 m0, s78, 16384
    s_add_u32 s79, s86, 1048576
    buffer_load_dwordx4 v12, s[24:27], s79 offen  lds
    v_exp_f32 v53, v53
    v_exp_f32 v54, v54
    v_exp_f32 v55, v55
    v_exp_f32 v24, v24
    v_exp_f32 v25, v25
    v_smfmac_f32_32x32x32_bf16 v[72:87], v[108:111], v[48:55], v8
    v_exp_f32 v26, v26
    v_exp_f32 v27, v27
    v_exp_f32 v28, v28
    v_mfma_f32_32x32x16_bf16 v[40:55], v[112:115], v[20:23], 0
    v_exp_f32 v29, v29
    v_exp_f32 v30, v30
    v_exp_f32 v31, v31
    v_exp_f32 v32, v32
    v_exp_f32 v33, v33
    v_smfmac_f32_32x32x32_bf16 v[56:71], v[116:119], v[24:31], v8
    v_exp_f32 v34, v34
    v_exp_f32 v35, v35
    buffer_load_dwordx4 v[100:103], v15, s[28:31], s81 offen offset:2048 sc1
    s_mov_b64 exec, s[84:85]
    buffer_load_dwordx4 v[104:107], v14, s[28:31], s81 offen offset:3072 sc1
    buffer_load_dwordx4 v[108:111], v14, s[28:31], s81 offen offset:3584 sc1
    s_mov_b64 exec, -1
    s_add_u32 s81, s81, 4096
    s_and_b32 s81, s81, 0x1ffff
    v_exp_f32 v36, v36
    s_add_u32 m0, s78, 18432
    s_add_u32 s79, s86, 1212416
    buffer_load_dwordx4 v12, s[24:27], s79 offen  lds
    s_add_u32 m0, s78, 20480
    s_add_u32 s79, s86, 1376256
    buffer_load_dwordx4 v12, s[24:27], s79 offen  lds
    s_add_u32 m0, s87, 65536
    s_add_u32 s79, s88, 0
    buffer_load_dwordx4 v13, s[20:23], s79 offen  lds
    s_add_u32 m0, s87, 69632
    s_add_u32 s79, s88, 88064
    buffer_load_dwordx4 v13, s[20:23], s79 offen  lds
    v_exp_f32 v37, v37
    v_exp_f32 v38, v38
    v_exp_f32 v39, v39
    v_exp_f32 v40, v40
    v_exp_f32 v41, v41
    v_smfmac_f32_32x32x32_bf16 v[56:71], v[120:123], v[32:39], v8
    v_exp_f32 v42, v42
    v_exp_f32 v43, v43
    v_exp_f32 v44, v44
    s_waitcnt vmcnt(27)
    v_mfma_f32_32x32x16_bf16 v[24:39], v[124:127], v[16:19], 0
    v_exp_f32 v45, v45
    v_exp_f32 v46, v46
    v_exp_f32 v47, v47
    v_exp_f32 v48, v48
    v_exp_f32 v49, v49
    v_smfmac_f32_32x32x32_bf16 v[72:87], v[116:119], v[40:47], v8
    v_exp_f32 v50, v50
    v_exp_f32 v51, v51
    v_exp_f32 v52, v52
    s_add_u32 m0, s87, 73728
    s_add_u32 s79, s88, 176128
    buffer_load_dwordx4 v13, s[20:23], s79 offen  lds
    s_add_u32 m0, s87, 77824
    s_add_u32 s79, s88, 264192
    buffer_load_dwordx4 v13, s[20:23], s79 offen  lds
    s_add_u32 m0, s87, 81920
    s_add_u32 s79, s88, 352256
    buffer_load_dwordx4 v13, s[20:23], s79 offen  lds
    s_add_u32 m0, s87, 86016
    s_add_u32 s79, s88, 440320
    buffer_load_dwordx4 v13, s[20:23], s79 offen  lds
    s_add_u32 m0, s87, 90112
    s_add_u32 s79, s88, 528384
    buffer_load_dwordx4 v13, s[20:23], s79 offen  lds
    v_exp_f32 v53, v53
    v_exp_f32 v54, v54
    v_exp_f32 v55, v55
    v_exp_f32 v24, v24
    v_exp_f32 v25, v25
    v_smfmac_f32_32x32x32_bf16 v[72:87], v[120:123], v[48:55], v8
    v_exp_f32 v26, v26
    v_exp_f32 v27, v27
    v_exp_f32 v28, v28
    v_mfma_f32_32x32x16_bf16 v[40:55], v[124:127], v[20:23], 0
    v_exp_f32 v29, v29
    v_exp_f32 v30, v30
    v_exp_f32 v31, v31
    v_exp_f32 v32, v32
    v_exp_f32 v33, v33
    v_smfmac_f32_32x32x32_bf16 v[56:71], v[128:131], v[24:31], v8
    v_exp_f32 v34, v34
    v_exp_f32 v35, v35
    v_exp_f32 v36, v36
    s_add_u32 m0, s87, 94208
    s_add_u32 s79, s88, 616448
    buffer_load_dwordx4 v13, s[20:23], s79 offen  lds
    s_add_u32 m0, s87, 98304
    s_add_u32 s79, s88, 704512
    buffer_load_dwordx4 v13, s[20:23], s79 offen  lds
    s_add_u32 m0, s87, 102400
    s_add_u32 s79, s88, 792576
    buffer_load_dwordx4 v13, s[20:23], s79 offen  lds
    s_add_u32 m0, s87, 106496
    s_add_u32 s79, s88, 880640
    buffer_load_dwordx4 v13, s[20:23], s79 offen  lds
    v_exp_f32 v37, v37
    v_exp_f32 v38, v38
    v_exp_f32 v39, v39
    v_exp_f32 v40, v40
    v_exp_f32 v41, v41
    v_smfmac_f32_32x32x32_bf16 v[56:71], v[132:135], v[32:39], v8
    v_exp_f32 v42, v42
    v_exp_f32 v43, v43
    v_exp_f32 v44, v44
    s_waitcnt vmcnt(25)
    v_mfma_f32_32x32x16_bf16 v[24:39], v[88:91], v[16:19], 0
    v_exp_f32 v45, v45
    v_exp_f32 v46, v46
    v_exp_f32 v47, v47
    v_exp_f32 v48, v48
    v_exp_f32 v49, v49
    v_smfmac_f32_32x32x32_bf16 v[72:87], v[128:131], v[40:47], v8
    v_exp_f32 v50, v50
    v_exp_f32 v51, v51
    v_exp_f32 v52, v52
    s_add_u32 m0, s87, 110592
    s_add_u32 s79, s88, 968704
    buffer_load_dwordx4 v13, s[20:23], s79 offen  lds
    s_add_u32 m0, s87, 114688
    s_add_u32 s79, s88, 1056768
    buffer_load_dwordx4 v13, s[20:23], s79 offen  lds
    s_add_u32 m0, s87, 118784
    s_add_u32 s79, s88, 1144832
    buffer_load_dwordx4 v13, s[20:23], s79 offen  lds
    s_add_u32 m0, s87, 122880
    s_add_u32 s79, s88, 1232896
    buffer_load_dwordx4 v13, s[20:23], s79 offen  lds
    s_add_u32 m0, s87, 126976
    s_add_u32 s79, s88, 1320960
    buffer_load_dwordx4 v13, s[20:23], s79 offen  lds
    v_exp_f32 v53, v53
    v_exp_f32 v54, v54
    v_exp_f32 v55, v55
    v_exp_f32 v24, v24
    v_exp_f32 v25, v25
    v_smfmac_f32_32x32x32_bf16 v[72:87], v[132:135], v[48:55], v8
    v_exp_f32 v26, v26
    v_exp_f32 v27, v27
    v_exp_f32 v28, v28
    v_mfma_f32_32x32x16_bf16 v[40:55], v[88:91], v[20:23], 0
    v_exp_f32 v29, v29
    v_exp_f32 v30, v30
    v_exp_f32 v31, v31
    v_exp_f32 v32, v32
    v_exp_f32 v33, v33
    v_smfmac_f32_32x32x32_bf16 v[56:71], v[92:95], v[24:31], v8
    v_exp_f32 v34, v34
    v_exp_f32 v35, v35
    v_exp_f32 v36, v36
    s_add_u32 s79, s96, 44160
    buffer_load_dword v251, v3, s[20:23], s79 offen
    v_exp_f32 v37, v37
    v_exp_f32 v38, v38
    v_exp_f32 v39, v39
    v_exp_f32 v40, v40
    v_exp_f32 v41, v41
    v_smfmac_f32_32x32x32_bf16 v[56:71], v[96:99], v[32:39], v8
    v_exp_f32 v42, v42
    v_exp_f32 v43, v43
    v_exp_f32 v44, v44
    s_waitcnt vmcnt(19)
    v_mfma_f32_32x32x16_bf16 v[24:39], v[100:103], v[16:19], 0
    v_exp_f32 v45, v45
    v_exp_f32 v46, v46
    v_exp_f32 v47, v47
    v_exp_f32 v48, v48
    v_exp_f32 v49, v49
    v_smfmac_f32_32x32x32_bf16 v[72:87], v[92:95], v[40:47], v8
    v_exp_f32 v50, v50
    v_exp_f32 v51, v51
    v_exp_f32 v52, v52
    v_exp_f32 v53, v53
    v_exp_f32 v54, v54
    v_exp_f32 v55, v55
    v_exp_f32 v24, v24
    v_exp_f32 v25, v25
    v_smfmac_f32_32x32x32_bf16 v[72:87], v[96:99], v[48:55], v8
    v_exp_f32 v26, v26
    v_exp_f32 v27, v27
    v_exp_f32 v28, v28
    v_mfma_f32_32x32x16_bf16 v[40:55], v[100:103], v[20:23], 0
    v_exp_f32 v29, v29
    v_exp_f32 v30, v30
    v_exp_f32 v31, v31
    v_exp_f32 v32, v32
    v_exp_f32 v33, v33
    v_smfmac_f32_32x32x32_bf16 v[56:71], v[104:107], v[24:31], v8
    v_exp_f32 v34, v34
    v_exp_f32 v35, v35
    v_exp_f32 v36, v36
    s_getpc_b64 s[4:5]
L_pc2:
    s_lshr_b32 s74, s2, 3
    s_lshl_b32 s74, s74, 2
    s_add_u32 s74, s74, s72
    s_lshl_b32 s74, s74, 7
    s_add_u32 s74, s74, L_attn_end-L_pc2
    v_lshl_add_u32 v10, v1, 14, s74
    v_min_u32 v10, L_code_end-L_pc2-4, v10
    s_mov_b64 exec, 3
    global_load_dword v251, v10, s[4:5]
    s_mov_b64 exec, -1
    v_exp_f32 v37, v37
    v_exp_f32 v38, v38
    v_exp_f32 v39, v39
    v_exp_f32 v40, v40
    v_exp_f32 v41, v41
    v_smfmac_f32_32x32x32_bf16 v[56:71], v[108:111], v[32:39], v8
    v_exp_f32 v42, v42
    v_exp_f32 v43, v43
    v_exp_f32 v44, v44
    v_exp_f32 v45, v45
    v_exp_f32 v46, v46
    v_exp_f32 v47, v47
    v_exp_f32 v48, v48
    v_exp_f32 v49, v49
    v_smfmac_f32_32x32x32_bf16 v[72:87], v[104:107], v[40:47], v8
    v_exp_f32 v50, v50
    v_exp_f32 v51, v51
    s_lshl_b32 s74, s3, 11
    v_add_u32 v10, s74, v246
    s_lshl_b32 s74, s3, 8
    v_add_u32 v11, s74, v249
    ds_write_b32 v11, v64 offset:16384
    ds_write_b128 v10, v[56:59] offset:0
    ds_write_b128 v10, v[60:63] offset:1024
    v_exp_f32 v52, v52
    v_exp_f32 v53, v53
    v_exp_f32 v54, v54
    v_exp_f32 v55, v55
    s_waitcnt vmcnt(2)
    s_setprio 0
    s_nop 0
    v_smfmac_f32_32x32x32_bf16 v[72:87], v[108:111], v[48:55], v8
    s_branch L_attn_end
L_p1_compute:
    s_add_u32 m0, s97, 65536
    s_add_u32 s79, s86, 1024
    buffer_load_dwordx4 v13, s[12:15], s79 offen  lds
    s_add_u32 m0, s97, 66560
    s_add_u32 s79, s86, 25600
    buffer_load_dwordx4 v13, s[12:15], s79 offen  lds
    s_add_u32 m0, s97, 67584
    s_add_u32 s79, s86, 50176
    buffer_load_dwordx4 v13, s[12:15], s79 offen  lds
    s_add_u32 m0, s97, 68608
    s_add_u32 s79, s86, 74752
    buffer_load_dwordx4 v13, s[12:15], s79 offen  lds
    s_add_u32 m0, s97, 81920
    s_add_u32 s79, s87, 1024
    buffer_load_dwordx4 v13, s[12:15], s79 offen  lds
    s_add_u32 m0, s97, 82944
    s_add_u32 s79, s87, 25600
    buffer_load_dwordx4 v13, s[12:15], s79 offen  lds
    s_add_u32 m0, s97, 83968
    s_add_u32 s79, s87, 50176
    buffer_load_dwordx4 v13, s[12:15], s79 offen  lds
    s_add_u32 m0, s97, 84992
    s_add_u32 s79, s87, 74752
    buffer_load_dwordx4 v13, s[12:15], s79 offen  lds
    s_add_u32 m0, s97, 98304
    s_add_u32 s79, s88, 1024
    buffer_load_dwordx4 v13, s[12:15], s79 offen  lds
    s_add_u32 m0, s97, 99328
    s_add_u32 s79, s88, 25600
    buffer_load_dwordx4 v13, s[12:15], s79 offen  lds
    s_add_u32 m0, s97, 100352
    s_add_u32 s79, s88, 50176
    buffer_load_dwordx4 v13, s[12:15], s79 offen  lds
    s_add_u32 m0, s97, 101376
    s_add_u32 s79, s88, 74752
    buffer_load_dwordx4 v13, s[12:15], s79 offen  lds
    s_waitcnt vmcnt(8) lgkmcnt(0)
    s_barrier
    ds_read_b128 v[16:19], v4 offset:0
    ds_read_b64_tr_b16 v[192:193], v8 offset:0
    ds_read_b64_tr_b16 v[194:195], v8 offset:512
    ds_read_b128 v[20:23], v5 offset:0
    ds_read_b64_tr_b16 v[196:197], v8 offset:2048
    ds_read_b64_tr_b16 v[198:199], v8 offset:2560
    ds_read_b128 v[24:27], v6 offset:0
    ds_read_b64_tr_b16 v[200:201], v8 offset:4096
    ds_read_b64_tr_b16 v[202:203], v8 offset:4608
    ds_read_b128 v[28:31], v7 offset:0
    ds_read_b64_tr_b16 v[204:205], v8 offset:6144
    ds_read_b64_tr_b16 v[206:207], v8 offset:6656
    s_waitcnt lgkmcnt(9)
    v_mfma_f32_32x32x16_bf16 v[144:159], v[192:195], v[16:19], 0
    ds_read_b128 v[32:35], v4 offset:4096
    ds_read_b64_tr_b16 v[224:225], v8 offset:8192
    ds_read_b64_tr_b16 v[226:227], v8 offset:8704
    s_waitcnt lgkmcnt(9)
    v_mfma_f32_32x32x16_bf16 v[144:159], v[196:199], v[20:23], v[144:159]
    ds_read_b128 v[36:39], v5 offset:4096
    ds_read_b64_tr_b16 v[228:229], v8 offset:10240
    ds_read_b64_tr_b16 v[230:231], v8 offset:10752
    s_waitcnt lgkmcnt(9)
    v_mfma_f32_32x32x16_bf16 v[144:159], v[200:203], v[24:27], v[144:159]
    ds_read_b128 v[40:43], v6 offset:4096
    ds_read_b64_tr_b16 v[192:193], v8 offset:12288
    ds_read_b64_tr_b16 v[194:195], v8 offset:12800
    s_mul_i32 s70, s70, 0x0019660d
    s_add_u32 s70, s70, 0x3c6ef35f
    v_mov_b32 v248, s70
    s_waitcnt lgkmcnt(9)
    v_mfma_f32_32x32x16_bf16 v[144:159], v[204:207], v[28:31], v[144:159]
    ds_read_b128 v[44:47], v7 offset:4096
    ds_read_b64_tr_b16 v[196:197], v8 offset:14336
    ds_read_b64_tr_b16 v[198:199], v8 offset:14848
    s_waitcnt lgkmcnt(9)
    v_mfma_f32_32x32x16_bf16 v[144:159], v[224:227], v[32:35], v[144:159]
    s_waitcnt vmcnt(4)
    s_barrier
    ds_read_b128 v[48:51], v4 offset:8192
    ds_read_b64_tr_b16 v[200:201], v8 offset:16384
    ds_read_b64_tr_b16 v[202:203], v8 offset:16896
    s_and_b32 s93, s67, 7
    s_waitcnt lgkmcnt(9)
    v_mfma_f32_32x32x16_bf16 v[144:159], v[228:231], v[36:39], v[144:159]
    ds_read_b128 v[52:55], v5 offset:8192
    ds_read_b64_tr_b16 v[204:205], v8 offset:18432
    ds_read_b64_tr_b16 v[206:207], v8 offset:18944
    s_lshl_b32 s98, s67, 2
    s_waitcnt lgkmcnt(9)
    v_mfma_f32_32x32x16_bf16 v[144:159], v[192:195], v[40:43], v[144:159]
    ds_read_b128 v[56:59], v6 offset:8192
    ds_read_b64_tr_b16 v[224:225], v8 offset:20480
    ds_read_b64_tr_b16 v[226:227], v8 offset:20992
    s_and_b32 s98, s98, 0x60
    s_waitcnt lgkmcnt(9)
    v_mfma_f32_32x32x16_bf16 v[144:159], v[196:199], v[44:47], v[144:159]
    ds_read_b128 v[60:63], v7 offset:8192
    ds_read_b64_tr_b16 v[228:229], v8 offset:22528
    ds_read_b64_tr_b16 v[230:231], v8 offset:23040
    s_add_u32 s93, s93, s98
    s_waitcnt lgkmcnt(9)
    v_mfma_f32_32x32x16_bf16 v[144:159], v[200:203], v[48:51], v[144:159]
    ds_read_b128 v[64:67], v4 offset:12288
    ds_read_b64_tr_b16 v[192:193], v8 offset:24576
    ds_read_b64_tr_b16 v[194:195], v8 offset:25088
    s_lshl_b32 s98, s66, 9
    s_waitcnt lgkmcnt(9)
    v_mfma_f32_32x32x16_bf16 v[144:159], v[204:207], v[52:55], v[144:159]
    ds_read_b128 v[68:71], v5 offset:12288
    ds_read_b64_tr_b16 v[196:197], v8 offset:26624
    ds_read_b64_tr_b16 v[198:199], v8 offset:27136
    s_lshl_b32 s79, s93, 2
    s_waitcnt lgkmcnt(9)
    v_mfma_f32_32x32x16_bf16 v[144:159], v[224:227], v[56:59], v[144:159]
    ds_read_b128 v[72:75], v6 offset:12288
    ds_read_b64_tr_b16 v[200:201], v8 offset:28672
    ds_read_b64_tr_b16 v[202:203], v8 offset:29184
    s_add_u32 s98, s98, s79
    s_waitcnt lgkmcnt(9)
    v_mfma_f32_32x32x16_bf16 v[144:159], v[228:231], v[60:63], v[144:159]
    ds_read_b128 v[76:79], v7 offset:12288
    ds_read_b64_tr_b16 v[204:205], v8 offset:30720
    ds_read_b64_tr_b16 v[206:207], v8 offset:31232
    s_waitcnt lgkmcnt(9)
    v_mfma_f32_32x32x16_bf16 v[144:159], v[192:195], v[64:67], v[144:159]
    s_waitcnt vmcnt(0)
    s_barrier
    ds_read_b128 v[80:83], v4 offset:16384
    ds_read_b64_tr_b16 v[224:225], v8 offset:32768
    ds_read_b64_tr_b16 v[226:227], v8 offset:33280
    s_add_u32 s98, s98, 16384
    s_waitcnt lgkmcnt(9)
    v_mfma_f32_32x32x16_bf16 v[144:159], v[196:199], v[68:71], v[144:159]
    ds_read_b128 v[84:87], v5 offset:16384
    ds_read_b64_tr_b16 v[228:229], v8 offset:34816
    ds_read_b64_tr_b16 v[230:231], v8 offset:35328
    s_lshl_b32 s99, s66, 9
    s_waitcnt lgkmcnt(9)
    v_mfma_f32_32x32x16_bf16 v[144:159], v[200:203], v[72:75], v[144:159]
    ds_read_b128 v[88:91], v6 offset:16384
    ds_read_b64_tr_b16 v[192:193], v8 offset:36864
    ds_read_b64_tr_b16 v[194:195], v8 offset:37376
    s_add_u32 s99, s99, 16384
    s_waitcnt lgkmcnt(9)
    v_mfma_f32_32x32x16_bf16 v[144:159], v[204:207], v[76:79], v[144:159]
    ds_read_b128 v[92:95], v7 offset:16384
    ds_read_b64_tr_b16 v[196:197], v8 offset:38912
    ds_read_b64_tr_b16 v[198:199], v8 offset:39424
    v_and_b32 v10, 7, v1
    s_waitcnt lgkmcnt(9)
    v_mfma_f32_32x32x16_bf16 v[144:159], v[224:227], v[80:83], v[144:159]
    ds_read_b128 v[96:99], v4 offset:20480
    ds_read_b64_tr_b16 v[200:201], v8 offset:40960
    ds_read_b64_tr_b16 v[202:203], v8 offset:41472
    v_lshrrev_b32 v11, 3, v1
    s_waitcnt lgkmcnt(9)
    v_mfma_f32_32x32x16_bf16 v[144:159], v[228:231], v[84:87], v[144:159]
    ds_read_b128 v[100:103], v5 offset:20480
    ds_read_b64_tr_b16 v[204:205], v8 offset:43008
    ds_read_b64_tr_b16 v[206:207], v8 offset:43520
    v_lshlrev_b32 v11, 7, v11
    s_waitcnt lgkmcnt(9)
    v_mfma_f32_32x32x16_bf16 v[144:159], v[192:195], v[88:91], v[144:159]
    ds_read_b128 v[104:107], v6 offset:20480
    ds_read_b64_tr_b16 v[224:225], v8 offset:45056
    ds_read_b64_tr_b16 v[226:227], v8 offset:45568
    v_lshl_add_u32 v216, v10, 2, v11
    s_waitcnt lgkmcnt(9)
    v_mfma_f32_32x32x16_bf16 v[144:159], v[196:199], v[92:95], v[144:159]
    ds_read_b128 v[108:111], v7 offset:20480
    ds_read_b64_tr_b16 v[228:229], v8 offset:47104
    ds_read_b64_tr_b16 v[230:231], v8 offset:47616
    s_waitcnt lgkmcnt(9)
    v_mfma_f32_32x32x16_bf16 v[144:159], v[200:203], v[96:99], v[144:159]
    s_barrier
    ds_read_b128 v[112:115], v4 offset:24576
    ds_read_b64_tr_b16 v[192:193], v9 offset:0
    ds_read_b64_tr_b16 v[194:195], v9 offset:512
    s_waitcnt lgkmcnt(9)
    v_mfma_f32_32x32x16_bf16 v[144:159], v[204:207], v[100:103], v[144:159]
    ds_read_b128 v[116:119], v5 offset:24576
    ds_read_b64_tr_b16 v[196:197], v9 offset:2048
    ds_read_b64_tr_b16 v[198:199], v9 offset:2560
    s_waitcnt lgkmcnt(9)
    v_mfma_f32_32x32x16_bf16 v[144:159], v[224:227], v[104:107], v[144:159]
    ds_read_b128 v[120:123], v6 offset:24576
    ds_read_b64_tr_b16 v[200:201], v9 offset:4096
    ds_read_b64_tr_b16 v[202:203], v9 offset:4608
    s_waitcnt lgkmcnt(9)
    v_mfma_f32_32x32x16_bf16 v[144:159], v[228:231], v[108:111], v[144:159]
    ds_read_b128 v[124:127], v7 offset:24576
    ds_read_b64_tr_b16 v[204:205], v9 offset:6144
    ds_read_b64_tr_b16 v[206:207], v9 offset:6656
    s_waitcnt lgkmcnt(9)
    v_mfma_f32_32x32x16_bf16 v[144:159], v[192:195], v[112:115], v[144:159]
    ds_read_b128 v[128:131], v4 offset:28672
    ds_read_b64_tr_b16 v[224:225], v9 offset:8192
    ds_read_b64_tr_b16 v[226:227], v9 offset:8704
    s_waitcnt lgkmcnt(9)
    v_mfma_f32_32x32x16_bf16 v[144:159], v[196:199], v[116:119], v[144:159]
    ds_read_b128 v[132:135], v5 offset:28672
    ds_read_b64_tr_b16 v[228:229], v9 offset:10240
    ds_read_b64_tr_b16 v[230:231], v9 offset:10752
    s_waitcnt lgkmcnt(9)
    v_mfma_f32_32x32x16_bf16 v[144:159], v[200:203], v[120:123], v[144:159]
    ds_read_b128 v[136:139], v6 offset:28672
    ds_read_b64_tr_b16 v[192:193], v9 offset:12288
    ds_read_b64_tr_b16 v[194:195], v9 offset:12800
    s_waitcnt lgkmcnt(9)
    v_mfma_f32_32x32x16_bf16 v[144:159], v[204:207], v[124:127], v[144:159]
    ds_read_b128 v[140:143], v7 offset:28672
    ds_read_b64_tr_b16 v[196:197], v9 offset:14336
    ds_read_b64_tr_b16 v[198:199], v9 offset:14848
    s_waitcnt lgkmcnt(9)
    v_mfma_f32_32x32x16_bf16 v[144:159], v[224:227], v[128:131], v[144:159]
    s_barrier
    ds_read_b64_tr_b16 v[200:201], v9 offset:16384
    ds_read_b64_tr_b16 v[202:203], v9 offset:16896
    ds_read_b64_tr_b16 v[204:205], v9 offset:18432
    ds_read_b64_tr_b16 v[206:207], v9 offset:18944
    s_waitcnt lgkmcnt(10)
    v_mfma_f32_32x32x16_bf16 v[144:159], v[228:231], v[132:135], v[144:159]
    ds_read_b64_tr_b16 v[224:225], v9 offset:20480
    ds_read_b64_tr_b16 v[226:227], v9 offset:20992
    ds_read_b64_tr_b16 v[228:229], v9 offset:22528
    ds_read_b64_tr_b16 v[230:231], v9 offset:23040
    s_waitcnt lgkmcnt(11)
    v_mfma_f32_32x32x16_bf16 v[144:159], v[192:195], v[136:139], v[144:159]
    ds_read_b64_tr_b16 v[192:193], v9 offset:24576
    ds_read_b64_tr_b16 v[194:195], v9 offset:25088
    s_waitcnt lgkmcnt(10)
    v_mfma_f32_32x32x16_bf16 v[144:159], v[196:199], v[140:143], v[144:159]
    ds_read_b64_tr_b16 v[196:197], v9 offset:26624
    ds_read_b64_tr_b16 v[198:199], v9 offset:27136
    s_waitcnt lgkmcnt(8)
    v_mfma_f32_32x32x16_bf16 v[160:175], v[16:19], v[200:203], 0
    ds_read_b64_tr_b16 v[200:201], v9 offset:28672
    ds_read_b64_tr_b16 v[202:203], v9 offset:29184
    v_mfma_f32_32x32x16_bf16 v[160:175], v[20:23], v[204:207], v[160:175]
    ds_read_b64_tr_b16 v[204:205], v9 offset:30720
    ds_read_b64_tr_b16 v[206:207], v9 offset:31232
    s_waitcnt lgkmcnt(8)
    v_mfma_f32_32x32x16_bf16 v[160:175], v[24:27], v[224:227], v[160:175]
    s_barrier
    ds_read_b64_tr_b16 v[224:225], v9 offset:32768
    ds_read_b64_tr_b16 v[226:227], v9 offset:33280
    v_mfma_f32_32x32x16_bf16 v[160:175], v[28:31], v[228:231], v[160:175]
    ds_read_b64_tr_b16 v[228:229], v9 offset:34816
    ds_read_b64_tr_b16 v[230:231], v9 offset:35328
    s_waitcnt lgkmcnt(8)
    v_mfma_f32_32x32x16_bf16 v[160:175], v[32:35], v[192:195], v[160:175]
    ds_read_b64_tr_b16 v[192:193], v9 offset:36864
    ds_read_b64_tr_b16 v[194:195], v9 offset:37376
    v_cvt_pk_bf16_f32 v144, v144, v145
    v_cvt_pk_bf16_f32 v145, v146, v147
    v_mfma_f32_32x32x16_bf16 v[160:175], v[36:39], v[196:199], v[160:175]
    ds_read_b64_tr_b16 v[196:197], v9 offset:38912
    ds_read_b64_tr_b16 v[198:199], v9 offset:39424
    v_cvt_pk_bf16_f32 v146, v148, v149
    v_cvt_pk_bf16_f32 v147, v150, v151
    s_waitcnt lgkmcnt(8)
    v_mfma_f32_32x32x16_bf16 v[160:175], v[40:43], v[200:203], v[160:175]
    ds_read_b64_tr_b16 v[200:201], v9 offset:40960
    ds_read_b64_tr_b16 v[202:203], v9 offset:41472
    v_cvt_pk_bf16_f32 v148, v152, v153
    v_cvt_pk_bf16_f32 v149, v154, v155
    v_mfma_f32_32x32x16_bf16 v[160:175], v[44:47], v[204:207], v[160:175]
    ds_read_b64_tr_b16 v[204:205], v9 offset:43008
    ds_read_b64_tr_b16 v[206:207], v9 offset:43520
    v_cvt_pk_bf16_f32 v150, v156, v157
    v_cvt_pk_bf16_f32 v151, v158, v159
    s_waitcnt lgkmcnt(8)
    v_mfma_f32_32x32x16_bf16 v[160:175], v[48:51], v[224:227], v[160:175]
    ds_read_b64_tr_b16 v[224:225], v9 offset:45056
    ds_read_b64_tr_b16 v[226:227], v9 offset:45568
    buffer_store_dwordx4 v[144:147], v208, s[28:31], s74 offen sc1
    v_mfma_f32_32x32x16_bf16 v[160:175], v[52:55], v[228:231], v[160:175]
    ds_read_b64_tr_b16 v[228:229], v9 offset:47104
    ds_read_b64_tr_b16 v[230:231], v9 offset:47616
    buffer_store_dwordx4 v[148:151], v208, s[28:31], s75 offen sc1
    s_waitcnt lgkmcnt(8)
    v_mfma_f32_32x32x16_bf16 v[160:175], v[56:59], v[192:195], v[160:175]
    s_barrier
    ds_read_b64_tr_b16 v[192:193], v8 offset:0
    ds_read_b64_tr_b16 v[194:195], v8 offset:512
    v_mfma_f32_32x32x16_bf16 v[160:175], v[60:63], v[196:199], v[160:175]
    ds_read_b64_tr_b16 v[196:197], v8 offset:2048
    ds_read_b64_tr_b16 v[198:199], v8 offset:2560
    s_waitcnt lgkmcnt(8)
    v_mfma_f32_32x32x16_bf16 v[160:175], v[64:67], v[200:203], v[160:175]
    ds_read_b64_tr_b16 v[200:201], v8 offset:4096
    ds_read_b64_tr_b16 v[202:203], v8 offset:4608
    v_mfma_f32_32x32x16_bf16 v[160:175], v[68:71], v[204:207], v[160:175]
    ds_read_b64_tr_b16 v[204:205], v8 offset:6144
    ds_read_b64_tr_b16 v[206:207], v8 offset:6656
    s_waitcnt lgkmcnt(8)
    v_mfma_f32_32x32x16_bf16 v[160:175], v[72:75], v[224:227], v[160:175]
    ds_read_b64_tr_b16 v[224:225], v8 offset:8192
    ds_read_b64_tr_b16 v[226:227], v8 offset:8704
    v_mfma_f32_32x32x16_bf16 v[160:175], v[76:79], v[228:231], v[160:175]
    ds_read_b64_tr_b16 v[228:229], v8 offset:10240
    ds_read_b64_tr_b16 v[230:231], v8 offset:10752
    s_waitcnt lgkmcnt(8)
    v_mfma_f32_32x32x16_bf16 v[160:175], v[80:83], v[192:195], v[160:175]
    ds_read_b64_tr_b16 v[192:193], v8 offset:12288
    ds_read_b64_tr_b16 v[194:195], v8 offset:12800
    v_mov_b32 v144, v214
    v_mfma_f32_32x32x16_bf16 v[160:175], v[84:87], v[196:199], v[160:175]
    ds_read_b64_tr_b16 v[196:197], v8 offset:14336
    ds_read_b64_tr_b16 v[198:199], v8 offset:14848
    v_mov_b32 v145, v214
    s_waitcnt lgkmcnt(8)
    v_mfma_f32_32x32x16_bf16 v[160:175], v[88:91], v[200:203], v[160:175]
    s_barrier
    ds_read_b64_tr_b16 v[200:201], v8 offset:16384
    ds_read_b64_tr_b16 v[202:203], v8 offset:16896
    v_mov_b32 v146, v214
    v_mfma_f32_32x32x16_bf16 v[160:175], v[92:95], v[204:207], v[160:175]
    ds_read_b64_tr_b16 v[204:205], v8 offset:18432
    ds_read_b64_tr_b16 v[206:207], v8 offset:18944
    v_mov_b32 v147, v214
    s_waitcnt lgkmcnt(8)
    v_mfma_f32_32x32x16_bf16 v[160:175], v[96:99], v[224:227], v[160:175]
    ds_read_b64_tr_b16 v[224:225], v8 offset:20480
    ds_read_b64_tr_b16 v[226:227], v8 offset:20992
    v_mov_b32 v152, v214
    v_mfma_f32_32x32x16_bf16 v[160:175], v[100:103], v[228:231], v[160:175]
    ds_read_b64_tr_b16 v[228:229], v8 offset:22528
    ds_read_b64_tr_b16 v[230:231], v8 offset:23040
    v_mov_b32 v153, v214
    s_waitcnt lgkmcnt(8)
    v_mfma_f32_32x32x16_bf16 v[160:175], v[104:107], v[192:195], v[160:175]
    ds_read_b64_tr_b16 v[192:193], v8 offset:24576
    ds_read_b64_tr_b16 v[194:195], v8 offset:25088
    v_mov_b32 v154, v214
    v_mfma_f32_32x32x16_bf16 v[160:175], v[108:111], v[196:199], v[160:175]
    ds_read_b64_tr_b16 v[196:197], v8 offset:26624
    ds_read_b64_tr_b16 v[198:199], v8 offset:27136
    v_mov_b32 v155, v214
    s_waitcnt lgkmcnt(8)
    v_mfma_f32_32x32x16_bf16 v[160:175], v[112:115], v[200:203], v[160:175]
    ds_read_b64_tr_b16 v[200:201], v8 offset:28672
    ds_read_b64_tr_b16 v[202:203], v8 offset:29184
    v_mov_b32 v156, v214
    v_mfma_f32_32x32x16_bf16 v[160:175], v[116:119], v[204:207], v[160:175]
    ds_read_b64_tr_b16 v[204:205], v8 offset:30720
    ds_read_b64_tr_b16 v[206:207], v8 offset:31232
    v_mov_b32 v157, v214
    s_waitcnt lgkmcnt(8)
    v_mfma_f32_32x32x16_bf16 v[160:175], v[120:123], v[224:227], v[160:175]
    s_barrier
    ds_read_b64_tr_b16 v[224:225], v8 offset:32768
    ds_read_b64_tr_b16 v[226:227], v8 offset:33280
    v_mov_b32 v158, v214
    v_mfma_f32_32x32x16_bf16 v[160:175], v[124:127], v[228:231], v[160:175]
    ds_read_b64_tr_b16 v[228:229], v8 offset:34816
    ds_read_b64_tr_b16 v[230:231], v8 offset:35328
    v_mov_b32 v159, v214
    s_waitcnt lgkmcnt(8)
    v_mfma_f32_32x32x16_bf16 v[160:175], v[128:131], v[192:195], v[160:175]
    ds_read_b64_tr_b16 v[192:193], v8 offset:36864
    ds_read_b64_tr_b16 v[194:195], v8 offset:37376
    v_mfma_f32_32x32x16_bf16 v[160:175], v[132:135], v[196:199], v[160:175]
    ds_read_b64_tr_b16 v[196:197], v8 offset:38912
    ds_read_b64_tr_b16 v[198:199], v8 offset:39424
    s_waitcnt lgkmcnt(8)
    v_mfma_f32_32x32x16_bf16 v[160:175], v[136:139], v[200:203], v[160:175]
    ds_read_b64_tr_b16 v[200:201], v8 offset:40960
    ds_read_b64_tr_b16 v[202:203], v8 offset:41472
    v_mfma_f32_32x32x16_bf16 v[160:175], v[140:143], v[204:207], v[160:175]
    ds_read_b64_tr_b16 v[204:205], v8 offset:43008
    ds_read_b64_tr_b16 v[206:207], v8 offset:43520
    s_waitcnt lgkmcnt(8)
    v_mfma_f32_32x32x16_bf16 v[176:191], v[224:227], v[16:19], 0
    ds_read_b64_tr_b16 v[224:225], v8 offset:45056
    ds_read_b64_tr_b16 v[226:227], v8 offset:45568
    v_mfma_f32_32x32x16_bf16 v[176:191], v[228:231], v[20:23], v[176:191]
    ds_read_b64_tr_b16 v[228:229], v8 offset:47104
    ds_read_b64_tr_b16 v[230:231], v8 offset:47616
    s_waitcnt lgkmcnt(8)
    v_mfma_f32_32x32x16_bf16 v[176:191], v[192:195], v[24:27], v[176:191]
    s_barrier
    ds_read_b64_tr_b16 v[192:193], v9 offset:0
    ds_read_b64_tr_b16 v[194:195], v9 offset:512
    v_mfma_f32_32x32x16_bf16 v[176:191], v[196:199], v[28:31], v[176:191]
    ds_read_b64_tr_b16 v[196:197], v9 offset:2048
    ds_read_b64_tr_b16 v[198:199], v9 offset:2560
    v_cvt_pk_bf16_f32 v160, v160, v161
    v_cvt_pk_bf16_f32 v161, v162, v163
    v_cvt_pk_bf16_f32 v162, v164, v165
    s_waitcnt lgkmcnt(8)
    v_mfma_f32_32x32x16_bf16 v[176:191], v[200:203], v[32:35], v[176:191]
    ds_read_b64_tr_b16 v[200:201], v9 offset:4096
    ds_read_b64_tr_b16 v[202:203], v9 offset:4608
    v_cvt_pk_bf16_f32 v163, v166, v167
    v_cvt_pk_bf16_f32 v164, v168, v169
    v_cvt_pk_bf16_f32 v165, v170, v171
    v_mfma_f32_32x32x16_bf16 v[176:191], v[204:207], v[36:39], v[176:191]
    ds_read_b64_tr_b16 v[204:205], v9 offset:6144
    ds_read_b64_tr_b16 v[206:207], v9 offset:6656
    v_cvt_pk_bf16_f32 v166, v172, v173
    v_cvt_pk_bf16_f32 v167, v174, v175
    buffer_store_dwordx4 v[160:163], v209, s[28:31], s74 offen offset:1024 sc1
    s_waitcnt lgkmcnt(8)
    v_mfma_f32_32x32x16_bf16 v[176:191], v[224:227], v[40:43], v[176:191]
    ds_read_b64_tr_b16 v[224:225], v9 offset:8192
    ds_read_b64_tr_b16 v[226:227], v9 offset:8704
    buffer_store_dwordx4 v[164:167], v209, s[28:31], s74 offen offset:1536 sc1
    v_mfma_f32_32x32x16_bf16 v[176:191], v[228:231], v[44:47], v[176:191]
    ds_read_b64_tr_b16 v[228:229], v9 offset:10240
    ds_read_b64_tr_b16 v[230:231], v9 offset:10752
    s_waitcnt lgkmcnt(8)
    v_mfma_f32_32x32x16_bf16 v[176:191], v[192:195], v[48:51], v[176:191]
    ds_read_b64_tr_b16 v[192:193], v9 offset:12288
    ds_read_b64_tr_b16 v[194:195], v9 offset:12800
    v_mov_b32 v48, 0
    v_mov_b32 v49, 0
    v_mov_b32 v50, 0
    v_mov_b32 v51, 0
    v_mfma_f32_32x32x16_bf16 v[176:191], v[196:199], v[52:55], v[176:191]
    ds_read_b64_tr_b16 v[196:197], v9 offset:14336
    ds_read_b64_tr_b16 v[198:199], v9 offset:14848
    v_mov_b32 v52, 0
    v_mov_b32 v53, 0
    v_mov_b32 v54, 0
    v_mov_b32 v55, 0
    s_waitcnt lgkmcnt(8)
    v_mfma_f32_32x32x16_bf16 v[176:191], v[200:203], v[56:59], v[176:191]
    s_barrier
    ds_read_b64_tr_b16 v[200:201], v9 offset:16384
    ds_read_b64_tr_b16 v[202:203], v9 offset:16896
    v_mov_b32 v56, 0
    v_mov_b32 v57, 0
    v_mov_b32 v58, 0
    v_mov_b32 v59, 0
    v_mfma_f32_32x32x16_bf16 v[176:191], v[204:207], v[60:63], v[176:191]
    ds_read_b64_tr_b16 v[204:205], v9 offset:18432
    ds_read_b64_tr_b16 v[206:207], v9 offset:18944
    v_mov_b32 v60, 0
    v_mov_b32 v61, 0
    v_mov_b32 v62, 0
    v_mov_b32 v63, 0
    s_waitcnt lgkmcnt(8)
    v_mfma_f32_32x32x16_bf16 v[176:191], v[224:227], v[64:67], v[176:191]
    ds_read_b64_tr_b16 v[224:225], v9 offset:20480
    ds_read_b64_tr_b16 v[226:227], v9 offset:20992
    v_mov_b32 v64, 0
    v_mov_b32 v65, 0
    v_mov_b32 v66, 0
    v_mov_b32 v67, 0
    v_mfma_f32_32x32x16_bf16 v[176:191], v[228:231], v[68:71], v[176:191]
    ds_read_b64_tr_b16 v[228:229], v9 offset:22528
    ds_read_b64_tr_b16 v[230:231], v9 offset:23040
    v_mov_b32 v68, 0
    v_mov_b32 v69, 0
    v_mov_b32 v70, 0
    v_mov_b32 v71, 0
    s_waitcnt lgkmcnt(8)
    v_mfma_f32_32x32x16_bf16 v[176:191], v[192:195], v[72:75], v[176:191]
    ds_read_b64_tr_b16 v[192:193], v9 offset:24576
    ds_read_b64_tr_b16 v[194:195], v9 offset:25088
    v_mov_b32 v72, 0
    v_mov_b32 v73, 0
    v_mov_b32 v74, 0
    v_mov_b32 v75, 0
    v_mfma_f32_32x32x16_bf16 v[176:191], v[196:199], v[76:79], v[176:191]
    ds_read_b64_tr_b16 v[196:197], v9 offset:26624
    ds_read_b64_tr_b16 v[198:199], v9 offset:27136
    v_mov_b32 v76, 0
    v_mov_b32 v77, 0
    v_mov_b32 v78, 0
    v_mov_b32 v79, 0
    s_waitcnt lgkmcnt(8)
    v_mfma_f32_32x32x16_bf16 v[176:191], v[200:203], v[80:83], v[176:191]
    ds_read_b64_tr_b16 v[200:201], v9 offset:28672
    ds_read_b64_tr_b16 v[202:203], v9 offset:29184
    v_mov_b32 v80, 0
    v_mov_b32 v81, 0
    v_mov_b32 v82, 0
    v_mov_b32 v83, 0
    v_mfma_f32_32x32x16_bf16 v[176:191], v[204:207], v[84:87], v[176:191]
    ds_read_b64_tr_b16 v[204:205], v9 offset:30720
    ds_read_b64_tr_b16 v[206:207], v9 offset:31232
    v_mov_b32 v84, 0
    v_mov_b32 v85, 0
    v_mov_b32 v86, 0
    v_mov_b32 v87, 0
    s_waitcnt lgkmcnt(8)
    v_mfma_f32_32x32x16_bf16 v[176:191], v[224:227], v[88:91], v[176:191]
    s_barrier
    ds_read_b64_tr_b16 v[224:225], v9 offset:32768
    ds_read_b64_tr_b16 v[226:227], v9 offset:33280
    v_mfma_f32_32x32x16_bf16 v[176:191], v[228:231], v[92:95], v[176:191]
    ds_read_b64_tr_b16 v[228:229], v9 offset:34816
    ds_read_b64_tr_b16 v[230:231], v9 offset:35328
    v_mov_b32 v92, v214
    v_mov_b32 v93, v214
    v_mov_b32 v94, v214
    v_mov_b32 v95, v214
    s_waitcnt lgkmcnt(8)
    v_mfma_f32_32x32x16_bf16 v[176:191], v[192:195], v[96:99], v[176:191]
    ds_read_b64_tr_b16 v[192:193], v9 offset:36864
    ds_read_b64_tr_b16 v[194:195], v9 offset:37376
    v_mov_b32 v96, v214
    v_mov_b32 v97, v214
    v_mov_b32 v98, v214
    v_mov_b32 v99, v214
    v_mfma_f32_32x32x16_bf16 v[176:191], v[196:199], v[100:103], v[176:191]
    ds_read_b64_tr_b16 v[196:197], v9 offset:38912
    ds_read_b64_tr_b16 v[198:199], v9 offset:39424
    s_waitcnt lgkmcnt(8)
    v_mfma_f32_32x32x16_bf16 v[176:191], v[200:203], v[104:107], v[176:191]
    ds_read_b64_tr_b16 v[200:201], v9 offset:40960
    ds_read_b64_tr_b16 v[202:203], v9 offset:41472
    v_mov_b32 v104, v214
    v_mov_b32 v105, v214
    v_mov_b32 v106, v214
    v_mov_b32 v107, v214
    v_mfma_f32_32x32x16_bf16 v[176:191], v[204:207], v[108:111], v[176:191]
    ds_read_b64_tr_b16 v[204:205], v9 offset:43008
    ds_read_b64_tr_b16 v[206:207], v9 offset:43520
    v_mov_b32 v108, v214
    v_mov_b32 v109, v214
    v_mov_b32 v110, v214
    v_mov_b32 v111, v214
    s_waitcnt lgkmcnt(8)
    v_mfma_f32_32x32x16_bf16 v[176:191], v[224:227], v[112:115], v[176:191]
    ds_read_b64_tr_b16 v[224:225], v9 offset:45056
    ds_read_b64_tr_b16 v[226:227], v9 offset:45568
    v_mfma_f32_32x32x16_bf16 v[176:191], v[228:231], v[116:119], v[176:191]
    ds_read_b64_tr_b16 v[228:229], v9 offset:47104
    ds_read_b64_tr_b16 v[230:231], v9 offset:47616
    v_mov_b32 v116, v214
    v_mov_b32 v117, v214
    v_mov_b32 v118, v214
    v_mov_b32 v119, v214
    s_waitcnt vmcnt(0)
    s_barrier
    s_waitcnt lgkmcnt(8)
    v_mfma_f32_32x32x16_bf16 v[176:191], v[192:195], v[120:123], v[176:191]
    v_mov_b32 v120, v214
    v_mov_b32 v121, v214
    v_mov_b32 v122, v214
    v_mov_b32 v123, v214
    v_mfma_f32_32x32x16_bf16 v[176:191], v[196:199], v[124:127], v[176:191]
    s_waitcnt lgkmcnt(4)
    v_mfma_f32_32x32x16_bf16 v[176:191], v[200:203], v[128:131], v[176:191]
    v_mov_b32 v128, v214
    v_mov_b32 v129, v214
    v_mov_b32 v130, v214
    v_mov_b32 v131, v214
    v_mfma_f32_32x32x16_bf16 v[176:191], v[204:207], v[132:135], v[176:191]
    v_mov_b32 v132, v214
    v_mov_b32 v133, v214
    v_mov_b32 v134, v214
    v_mov_b32 v135, v214
    s_waitcnt lgkmcnt(0)
    v_mfma_f32_32x32x16_bf16 v[176:191], v[224:227], v[136:139], v[176:191]
    v_mfma_f32_32x32x16_bf16 v[176:191], v[228:231], v[140:143], v[176:191]
    v_mov_b32 v140, v214
    v_mov_b32 v141, v214
    v_mov_b32 v142, v214
    v_mov_b32 v143, v214
    buffer_load_dwordx4 v[136:139], v15, s[28:31], s62 offen offset:0 sc1
    s_mov_b64 exec, s[84:85]
    buffer_load_dwordx4 v[140:143], v14, s[28:31], s62 offen offset:1024 sc1
    buffer_load_dwordx4 v[144:147], v14, s[28:31], s62 offen offset:1536 sc1
    s_mov_b64 exec, -1
    buffer_load_dwordx4 v[148:151], v15, s[28:31], s62 offen offset:2048 sc1
    s_mov_b64 exec, s[84:85]
    buffer_load_dwordx4 v[152:155], v14, s[28:31], s62 offen offset:3072 sc1
    buffer_load_dwordx4 v[156:159], v14, s[28:31], s62 offen offset:3584 sc1
    s_mov_b64 exec, -1
    v_mov_b32 v8, 0xdddddddd
    v_pk_mul_f32 v[176:177], v[176:177], v[212:213]
    v_pk_mul_f32 v[178:179], v[178:179], v[212:213]
    v_pk_mul_f32 v[180:181], v[180:181], v[212:213]
    v_pk_mul_f32 v[182:183], v[182:183], v[212:213]
    v_pk_mul_f32 v[184:185], v[184:185], v[212:213]
    v_pk_mul_f32 v[186:187], v[186:187], v[212:213]
    v_pk_mul_f32 v[188:189], v[188:189], v[212:213]
    v_pk_mul_f32 v[190:191], v[190:191], v[212:213]
    v_cvt_pk_bf16_f32 v176, v176, v177
    v_cvt_pk_bf16_f32 v177, v178, v179
    v_cvt_pk_bf16_f32 v178, v180, v181
    v_cvt_pk_bf16_f32 v179, v182, v183
    v_cvt_pk_bf16_f32 v180, v184, v185
    v_cvt_pk_bf16_f32 v181, v186, v187
    v_cvt_pk_bf16_f32 v182, v188, v189
    v_cvt_pk_bf16_f32 v183, v190, v191
    ds_write_b128 v210, v[176:179] offset:32768
    ds_write_b128 v210, v[180:183] offset:33792
    s_waitcnt lgkmcnt(0)
    s_barrier
    v_xor_b32 v10, 4096, v215
    ds_read_b128 v[20:23], v215 offset:32768
    ds_read_b128 v[16:19], v10 offset:32768
    buffer_load_dwordx4 v[252:255], v2, s[8:11], s83 offen
    v_and_b32 v10, 0x70, v246
    s_lshl_b32 s79, s69, 7
    buffer_load_dwordx4 v[236:239], v10, s[40:43], s79 offen
    v_and_b32 v10, 0x13, v1
    v_bfe_u32 v11, v1, 2, 1
    v_lshl_add_u32 v10, v11, 3, v10
    v_bfe_u32 v11, v1, 3, 1
    v_lshl_add_u32 v10, v11, 2, v10
    v_lshlrev_b32 v10, 1, v10
    s_lshr_b32 s79, s3, 1
    s_add_u32 s79, s79, s71
    s_lshl_b32 s79, s79, 6
    buffer_load_ushort v232, v10, s[36:39], s79 offen offset:0
    buffer_load_ushort v233, v10, s[36:39], s79 offen offset:128
    buffer_load_ushort v234, v10, s[36:39], s79 offen offset:256
    s_setprio 2
    s_mov_b32 s96, 1
    s_mov_b32 s80, 1
    s_mov_b32 s101, 0
    s_waitcnt vmcnt(8) lgkmcnt(0)
    v_mfma_f32_32x32x16_bf16 v[24:39], v[136:139], v[16:19], 0
    s_nop 7
    s_nop 3
    v_exp_f32 v24, v24
    v_exp_f32 v25, v25
    v_smfmac_f32_32x32x32_bf16 v[72:87], v[132:135], v[48:55], v8
    v_exp_f32 v26, v26
    v_exp_f32 v27, v27
    v_exp_f32 v28, v28
    v_mfma_f32_32x32x16_bf16 v[40:55], v[136:139], v[20:23], 0
    v_exp_f32 v29, v29
    v_exp_f32 v30, v30
    v_exp_f32 v31, v31
    v_exp_f32 v32, v32
    v_exp_f32 v33, v33
    v_smfmac_f32_32x32x32_bf16 v[56:71], v[140:143], v[24:31], v8
    v_exp_f32 v34, v34
    v_exp_f32 v35, v35
    v_exp_f32 v36, v36
    v_exp_f32 v37, v37
    v_exp_f32 v38, v38
    v_exp_f32 v39, v39
    v_exp_f32 v40, v40
    v_exp_f32 v41, v41
    v_smfmac_f32_32x32x32_bf16 v[56:71], v[144:147], v[32:39], v8
    v_exp_f32 v42, v42
    v_exp_f32 v43, v43
    v_exp_f32 v44, v44
    s_waitcnt vmcnt(5)
    v_mfma_f32_32x32x16_bf16 v[24:39], v[148:151], v[16:19], 0
    v_exp_f32 v45, v45
    v_exp_f32 v46, v46
    v_exp_f32 v47, v47
    v_exp_f32 v48, v48
    v_exp_f32 v49, v49
    v_smfmac_f32_32x32x32_bf16 v[72:87], v[140:143], v[40:47], v8
    v_exp_f32 v50, v50
    v_exp_f32 v51, v51
    v_exp_f32 v52, v52
    v_exp_f32 v53, v53
    v_exp_f32 v54, v54
    v_exp_f32 v55, v55
    s_barrier
    buffer_load_dwordx4 v[88:91], v15, s[28:31], s81 offen offset:0 sc1
    s_mov_b64 exec, s[84:85]
    buffer_load_dwordx4 v[92:95], v14, s[28:31], s81 offen offset:1024 sc1
    buffer_load_dwordx4 v[96:99], v14, s[28:31], s81 offen offset:1536 sc1
    s_mov_b64 exec, -1
    buffer_load_dwordx4 v[100:103], v15, s[28:31], s81 offen offset:2048 sc1
    s_mov_b64 exec, s[84:85]
    buffer_load_dwordx4 v[104:107], v14, s[28:31], s81 offen offset:3072 sc1
    buffer_load_dwordx4 v[108:111], v14, s[28:31], s81 offen offset:3584 sc1
    s_mov_b64 exec, -1
    s_add_u32 s81, s81, 4096
    s_and_b32 s81, s81, 0x1ffff
    s_cmp_eq_u32 s81, s62
    s_cselect_b32 s81, s63, s81
    buffer_load_dwordx4 v[112:115], v15, s[28:31], s81 offen offset:0 sc1
    s_mov_b64 exec, s[84:85]
    buffer_load_dwordx4 v[116:119], v14, s[28:31], s81 offen offset:1024 sc1
    buffer_load_dwordx4 v[120:123], v14, s[28:31], s81 offen offset:1536 sc1
    s_mov_b64 exec, -1
    buffer_load_dwordx4 v[124:127], v15, s[28:31], s81 offen offset:2048 sc1
    s_mov_b64 exec, s[84:85]
    buffer_load_dwordx4 v[128:131], v14, s[28:31], s81 offen offset:3072 sc1
    buffer_load_dwordx4 v[132:135], v14, s[28:31], s81 offen offset:3584 sc1
    s_mov_b64 exec, -1
    s_add_u32 s81, s81, 4096
    s_and_b32 s81, s81, 0x1ffff
    s_cmp_eq_u32 s81, s62
    s_cselect_b32 s81, s63, s81
    v_exp_f32 v24, v24
    v_exp_f32 v25, v25
    v_smfmac_f32_32x32x32_bf16 v[72:87], v[144:147], v[48:55], v8
    v_exp_f32 v26, v26
    v_exp_f32 v27, v27
    v_exp_f32 v28, v28
    v_mfma_f32_32x32x16_bf16 v[40:55], v[148:151], v[20:23], 0
    v_exp_f32 v29, v29
    v_exp_f32 v30, v30
    v_exp_f32 v31, v31
    v_exp_f32 v32, v32
    v_exp_f32 v33, v33
    v_smfmac_f32_32x32x32_bf16 v[56:71], v[152:155], v[24:31], v8
    v_exp_f32 v34, v34
    v_exp_f32 v35, v35
    buffer_load_dwordx4 v[136:139], v15, s[28:31], s81 offen offset:0 sc1
    s_mov_b64 exec, s[84:85]
    buffer_load_dwordx4 v[140:143], v14, s[28:31], s81 offen offset:1024 sc1
    buffer_load_dwordx4 v[144:147], v14, s[28:31], s81 offen offset:1536 sc1
    s_mov_b64 exec, -1
    v_exp_f32 v36, v36
    v_exp_f32 v37, v37
    v_exp_f32 v38, v38
    v_exp_f32 v39, v39
    v_exp_f32 v40, v40
    v_exp_f32 v41, v41
    v_smfmac_f32_32x32x32_bf16 v[56:71], v[156:159], v[32:39], v8
    v_exp_f32 v42, v42
    v_exp_f32 v43, v43
    v_exp_f32 v44, v44
    s_waitcnt vmcnt(12)
    v_mfma_f32_32x32x16_bf16 v[24:39], v[88:91], v[16:19], 0
    v_exp_f32 v45, v45
    v_exp_f32 v46, v46
    v_exp_f32 v47, v47
    v_exp_f32 v48, v48
    v_exp_f32 v49, v49
    v_smfmac_f32_32x32x32_bf16 v[72:87], v[152:155], v[40:47], v8
    v_exp_f32 v50, v50
    v_exp_f32 v51, v51
    v_exp_f32 v52, v52
    v_exp_f32 v53, v53
    v_exp_f32 v54, v54
    v_exp_f32 v55, v55
    s_branch L_attn
L_attn_s0:
    s_barrier
    s_setprio 2
    s_mov_b32 s80, 3
    s_branch L_attn
L_attn_s1:
    s_barrier
    s_setprio 2
    s_and_b32 s79, s2, 1
    s_lshl_b32 s79, s79, 13
    v_add_u32 v10, s79, v12
    s_sub_u32 s79, 8192, s79
    v_add_u32 v11, s79, v12
    ds_read_b64_tr_b16 v[160:161], v10 offset:0
    ds_read_b64_tr_b16 v[162:163], v10 offset:512
    ds_read_b64_tr_b16 v[164:165], v10 offset:2048
    ds_read_b64_tr_b16 v[166:167], v10 offset:2560
    ds_read_b64_tr_b16 v[168:169], v10 offset:4096
    ds_read_b64_tr_b16 v[170:171], v10 offset:4608
    ds_read_b64_tr_b16 v[172:173], v10 offset:6144
    ds_read_b64_tr_b16 v[174:175], v10 offset:6656
    ds_read_b64_tr_b16 v[176:177], v11 offset:0
    ds_read_b64_tr_b16 v[178:179], v11 offset:512
    ds_read_b64_tr_b16 v[180:181], v11 offset:2048
    ds_read_b64_tr_b16 v[182:183], v11 offset:2560
    ds_read_b64_tr_b16 v[184:185], v11 offset:4096
    ds_read_b64_tr_b16 v[186:187], v11 offset:4608
    ds_read_b64_tr_b16 v[188:189], v11 offset:6144
    ds_read_b64_tr_b16 v[190:191], v11 offset:6656
    ds_read_b64_tr_b16 v[192:193], v10 offset:16384
    ds_read_b64_tr_b16 v[194:195], v10 offset:16896
    ds_read_b64_tr_b16 v[196:197], v10 offset:18432
    ds_read_b64_tr_b16 v[198:199], v10 offset:18944
    ds_read_b64_tr_b16 v[200:201], v10 offset:20480
    ds_read_b64_tr_b16 v[202:203], v10 offset:20992
    ds_read_b64_tr_b16 v[204:205], v10 offset:22528
    ds_read_b64_tr_b16 v[206:207], v10 offset:23040
    ds_read_b64_tr_b16 v[208:209], v11 offset:16384
    ds_read_b64_tr_b16 v[210:211], v11 offset:16896
    ds_read_b64_tr_b16 v[212:213], v11 offset:18432
    ds_read_b64_tr_b16 v[214:215], v11 offset:18944
    ds_read_b64_tr_b16 v[216:217], v11 offset:20480
    ds_read_b64_tr_b16 v[218:219], v11 offset:20992
    ds_read_b64_tr_b16 v[220:221], v11 offset:22528
    ds_read_b64_tr_b16 v[222:223], v11 offset:23040
    s_lshl_b32 s60, s68, 6
    s_add_u32 s60, s60, 4096
    s_lshl_b32 s61, s67, 6
    s_add_u32 s61, s61, 4096
    s_mov_b32 s93, 0
    s_load_dwordx2 s[56:57], s[64:65], s60
    s_load_dwordx2 s[58:59], s[64:65], s61
    s_mov_b32 s80, 1
    s_branch L_attn
L_attn_s2:
L_hp_13:
    s_waitcnt lgkmcnt(0)
    s_cmp_eq_u32 s56, s70
    s_cselect_b32 s56, 8192, 0
    s_cmp_eq_u32 s57, s70
    s_cselect_b32 s57, 8192, 0
    s_cmp_eq_u32 s58, s70
    s_cselect_b32 s58, 8192, 0
    s_cmp_eq_u32 s59, s70
    s_cselect_b32 s59, 8192, 0
    s_or_b32 s56, s56, s57
    s_or_b32 s58, s58, s59
    s_and_b32 s56, s56, s58
    s_cbranch_scc1 L_hok_14
    s_add_u32 s93, s93, 1
    s_cmp_gt_u32 s93, 200000
    s_cbranch_scc1 L_hok_14
    s_load_dwordx2 s[56:57], s[64:65], s60 glc
    s_load_dwordx2 s[58:59], s[64:65], s61 glc
    s_branch L_hp_13
L_hok_14:
    s_lshl_b32 s60, s68, 20
    s_add_u32 s60, s60, s57
    s_lshl_b32 s61, s67, 20
    s_add_u32 s61, s61, s59
    s_add_u32 s82, s82, s61
    s_barrier
    s_setprio 2
    s_mov_b32 s96, 0
    s_mov_b32 s80, 2
.p2align 4
L_attn:
    v_exp_f32 v24, v24
    v_exp_f32 v25, v25
    v_smfmac_f32_32x32x32_bf16 v[72:87], v[156:159], v[48:55], v8
    v_exp_f32 v26, v26
    v_exp_f32 v27, v27
    v_exp_f32 v28, v28
    v_mfma_f32_32x32x16_bf16 v[40:55], v[88:91], v[20:23], 0
    v_exp_f32 v29, v29
    v_exp_f32 v30, v30
    v_exp_f32 v31, v31
    v_exp_f32 v32, v32
    v_exp_f32 v33, v33
    v_smfmac_f32_32x32x32_bf16 v[56:71], v[92:95], v[24:31], v8
    v_exp_f32 v34, v34
    v_exp_f32 v35, v35
    buffer_load_dwordx4 v[148:151], v15, s[28:31], s81 offen offset:2048 sc1
    s_mov_b64 exec, s[84:85]
    buffer_load_dwordx4 v[152:155], v14, s[28:31], s81 offen offset:3072 sc1
    buffer_load_dwordx4 v[156:159], v14, s[28:31], s81 offen offset:3584 sc1
    s_mov_b64 exec, -1
    s_add_u32 s81, s81, 4096
    s_and_b32 s81, s81, 0x1ffff
    s_cmp_eq_u32 s81, s62
    s_cselect_b32 s81, s63, s81
    v_exp_f32 v36, v36
    v_exp_f32 v37, v37
    v_exp_f32 v38, v38
    v_exp_f32 v39, v39
    v_exp_f32 v40, v40
    v_exp_f32 v41, v41
    v_smfmac_f32_32x32x32_bf16 v[56:71], v[96:99], v[32:39], v8
    v_exp_f32 v42, v42
    v_exp_f32 v43, v43
    v_exp_f32 v44, v44
    s_waitcnt vmcnt(12)
    v_mfma_f32_32x32x16_bf16 v[24:39], v[100:103], v[16:19], 0
    v_exp_f32 v45, v45
    v_exp_f32 v46, v46
    v_exp_f32 v47, v47
    v_exp_f32 v48, v48
    v_exp_f32 v49, v49
    v_smfmac_f32_32x32x32_bf16 v[72:87], v[92:95], v[40:47], v8
    v_exp_f32 v50, v50
    v_exp_f32 v51, v51
    v_exp_f32 v52, v52
    v_exp_f32 v53, v53
    v_exp_f32 v54, v54
    v_exp_f32 v55, v55
    v_exp_f32 v24, v24
    v_exp_f32 v25, v25
    v_smfmac_f32_32x32x32_bf16 v[72:87], v[96:99], v[48:55], v8
    v_exp_f32 v26, v26
    v_exp_f32 v27, v27
    v_exp_f32 v28, v28
    v_mfma_f32_32x32x16_bf16 v[40:55], v[100:103], v[20:23], 0
    v_exp_f32 v29, v29
    v_exp_f32 v30, v30
    v_exp_f32 v31, v31
    v_exp_f32 v32, v32
    v_exp_f32 v33, v33
    v_smfmac_f32_32x32x32_bf16 v[56:71], v[104:107], v[24:31], v8
    v_exp_f32 v34, v34
    v_exp_f32 v35, v35
    buffer_load_dwordx4 v[88:91], v15, s[28:31], s81 offen offset:0 sc1
    s_mov_b64 exec, s[84:85]
    buffer_load_dwordx4 v[92:95], v14, s[28:31], s81 offen offset:1024 sc1
    buffer_load_dwordx4 v[96:99], v14, s[28:31], s81 offen offset:1536 sc1
    s_mov_b64 exec, -1
    v_exp_f32 v36, v36
    v_exp_f32 v37, v37
    v_exp_f32 v38, v38
    v_exp_f32 v39, v39
    v_exp_f32 v40, v40
    v_exp_f32 v41, v41
    v_smfmac_f32_32x32x32_bf16 v[56:71], v[108:111], v[32:39], v8
    v_exp_f32 v42, v42
    v_exp_f32 v43, v43
    v_exp_f32 v44, v44
    s_waitcnt vmcnt(12)
    v_mfma_f32_32x32x16_bf16 v[24:39], v[112:115], v[16:19], 0
    v_exp_f32 v45, v45
    v_exp_f32 v46, v46
    v_exp_f32 v47, v47
    v_exp_f32 v48, v48
    v_exp_f32 v49, v49
    v_smfmac_f32_32x32x32_bf16 v[72:87], v[104:107], v[40:47], v8
    v_exp_f32 v50, v50
    v_exp_f32 v51, v51
    v_exp_f32 v52, v52
    v_exp_f32 v53, v53
    v_exp_f32 v54, v54
    v_exp_f32 v55, v55
    v_exp_f32 v24, v24
    v_exp_f32 v25, v25
    v_smfmac_f32_32x32x32_bf16 v[72:87], v[108:111], v[48:55], v8
    v_exp_f32 v26, v26
    v_exp_f32 v27, v27
    v_exp_f32 v28, v28
    v_mfma_f32_32x32x16_bf16 v[40:55], v[112:115], v[20:23], 0
    v_exp_f32 v29, v29
    v_exp_f32 v30, v30
    v_exp_f32 v31, v31
    v_exp_f32 v32, v32
    v_exp_f32 v33, v33
    v_smfmac_f32_32x32x32_bf16 v[56:71], v[116:119], v[24:31], v8
    v_exp_f32 v34, v34
    v_exp_f32 v35, v35
    buffer_load_dwordx4 v[100:103], v15, s[28:31], s81 offen offset:2048 sc1
    s_mov_b64 exec, s[84:85]
    buffer_load_dwordx4 v[104:107], v14, s[28:31], s81 offen offset:3072 sc1
    buffer_load_dwordx4 v[108:111], v14, s[28:31], s81 offen offset:3584 sc1
    s_mov_b64 exec, -1
    s_add_u32 s81, s81, 4096
    s_and_b32 s81, s81, 0x1ffff
    s_cmp_eq_u32 s81, s62
    s_cselect_b32 s81, s63, s81
    v_exp_f32 v36, v36
    v_exp_f32 v37, v37
    v_exp_f32 v38, v38
    v_exp_f32 v39, v39
    v_exp_f32 v40, v40
    v_exp_f32 v41, v41
    v_smfmac_f32_32x32x32_bf16 v[56:71], v[120:123], v[32:39], v8
    v_exp_f32 v42, v42
    v_exp_f32 v43, v43
    v_exp_f32 v44, v44
    s_waitcnt vmcnt(12)
    v_mfma_f32_32x32x16_bf16 v[24:39], v[124:127], v[16:19], 0
    v_exp_f32 v45, v45
    v_exp_f32 v46, v46
    v_exp_f32 v47, v47
    v_exp_f32 v48, v48
    v_exp_f32 v49, v49
    v_smfmac_f32_32x32x32_bf16 v[72:87], v[116:119], v[40:47], v8
    v_exp_f32 v50, v50
    v_exp_f32 v51, v51
    v_exp_f32 v52, v52
    v_exp_f32 v53, v53
    v_exp_f32 v54, v54
    v_exp_f32 v55, v55
    v_exp_f32 v24, v24
    v_exp_f32 v25, v25
    v_smfmac_f32_32x32x32_bf16 v[72:87], v[120:123], v[48:55], v8
    v_exp_f32 v26, v26
    v_exp_f32 v27, v27
    v_exp_f32 v28, v28
    v_mfma_f32_32x32x16_bf16 v[40:55], v[124:127], v[20:23], 0
    v_exp_f32 v29, v29
    v_exp_f32 v30, v30
    v_exp_f32 v31, v31
    v_exp_f32 v32, v32
    v_exp_f32 v33, v33
    v_smfmac_f32_32x32x32_bf16 v[56:71], v[128:131], v[24:31], v8
    v_exp_f32 v34, v34
    v_exp_f32 v35, v35
    buffer_load_dwordx4 v[112:115], v15, s[28:31], s81 offen offset:0 sc1
    s_mov_b64 exec, s[84:85]
    buffer_load_dwordx4 v[116:119], v14, s[28:31], s81 offen offset:1024 sc1
    buffer_load_dwordx4 v[120:123], v14, s[28:31], s81 offen offset:1536 sc1
    s_mov_b64 exec, -1
    v_exp_f32 v36, v36
    v_exp_f32 v37, v37
    v_exp_f32 v38, v38
    v_exp_f32 v39, v39
    v_exp_f32 v40, v40
    v_exp_f32 v41, v41
    v_smfmac_f32_32x32x32_bf16 v[56:71], v[132:135], v[32:39], v8
    v_exp_f32 v42, v42
    v_exp_f32 v43, v43
    v_exp_f32 v44, v44
    s_waitcnt vmcnt(12)
    v_mfma_f32_32x32x16_bf16 v[24:39], v[136:139], v[16:19], 0
    v_exp_f32 v45, v45
    v_exp_f32 v46, v46
    v_exp_f32 v47, v47
    v_exp_f32 v48, v48
    v_exp_f32 v49, v49
    v_smfmac_f32_32x32x32_bf16 v[72:87], v[128:131], v[40:47], v8
    v_exp_f32 v50, v50
    v_exp_f32 v51, v51
    v_exp_f32 v52, v52
    v_exp_f32 v53, v53
    v_exp_f32 v54, v54
    v_exp_f32 v55, v55
    v_exp_f32 v24, v24
    v_exp_f32 v25, v25
    v_smfmac_f32_32x32x32_bf16 v[72:87], v[132:135], v[48:55], v8
    v_exp_f32 v26, v26
    v_exp_f32 v27, v27
    v_exp_f32 v28, v28
    v_mfma_f32_32x32x16_bf16 v[40:55], v[136:139], v[20:23], 0
    v_exp_f32 v29, v29
    v_exp_f32 v30, v30
    v_exp_f32 v31, v31
    v_exp_f32 v32, v32
    v_exp_f32 v33, v33
    v_smfmac_f32_32x32x32_bf16 v[56:71], v[140:143], v[24:31], v8
    v_exp_f32 v34, v34
    v_exp_f32 v35, v35
    buffer_load_dwordx4 v[124:127], v15, s[28:31], s81 offen offset:2048 sc1
    s_mov_b64 exec, s[84:85]
    buffer_load_dwordx4 v[128:131], v14, s[28:31], s81 offen offset:3072 sc1
    buffer_load_dwordx4 v[132:135], v14, s[28:31], s81 offen offset:3584 sc1
    s_mov_b64 exec, -1
    s_add_u32 s81, s81, 4096
    s_and_b32 s81, s81, 0x1ffff
    s_cmp_eq_u32 s81, s62
    s_cselect_b32 s81, s63, s81
    v_exp_f32 v36, v36
    v_exp_f32 v37, v37
    v_exp_f32 v38, v38
    v_exp_f32 v39, v39
    v_exp_f32 v40, v40
    v_exp_f32 v41, v41
    v_smfmac_f32_32x32x32_bf16 v[56:71], v[144:147], v[32:39], v8
    v_exp_f32 v42, v42
    v_exp_f32 v43, v43
    v_exp_f32 v44, v44
    s_waitcnt vmcnt(12)
    v_mfma_f32_32x32x16_bf16 v[24:39], v[148:151], v[16:19], 0
    v_exp_f32 v45, v45
    v_exp_f32 v46, v46
    v_exp_f32 v47, v47
    v_exp_f32 v48, v48
    v_exp_f32 v49, v49
    v_smfmac_f32_32x32x32_bf16 v[72:87], v[140:143], v[40:47], v8
    v_exp_f32 v50, v50
    v_exp_f32 v51, v51
    v_exp_f32 v52, v52
    v_exp_f32 v53, v53
    v_exp_f32 v54, v54
    v_exp_f32 v55, v55
    s_cmp_lg_u32 s80, s96
    s_cbranch_scc1 L_keep
    s_setprio 0
L_keep:
    v_exp_f32 v24, v24
    v_exp_f32 v25, v25
    v_smfmac_f32_32x32x32_bf16 v[72:87], v[144:147], v[48:55], v8
    v_exp_f32 v26, v26
    v_exp_f32 v27, v27
    v_exp_f32 v28, v28
    v_mfma_f32_32x32x16_bf16 v[40:55], v[148:151], v[20:23], 0
    v_exp_f32 v29, v29
    v_exp_f32 v30, v30
    v_exp_f32 v31, v31
    v_exp_f32 v32, v32
    v_exp_f32 v33, v33
    v_smfmac_f32_32x32x32_bf16 v[56:71], v[152:155], v[24:31], v8
    v_exp_f32 v34, v34
    v_exp_f32 v35, v35
    buffer_load_dwordx4 v[136:139], v15, s[28:31], s81 offen offset:0 sc1
    s_mov_b64 exec, s[84:85]
    buffer_load_dwordx4 v[140:143], v14, s[28:31], s81 offen offset:1024 sc1
    buffer_load_dwordx4 v[144:147], v14, s[28:31], s81 offen offset:1536 sc1
    s_mov_b64 exec, -1
    v_exp_f32 v36, v36
    v_exp_f32 v37, v37
    v_exp_f32 v38, v38
    v_exp_f32 v39, v39
    v_exp_f32 v40, v40
    v_exp_f32 v41, v41
    v_smfmac_f32_32x32x32_bf16 v[56:71], v[156:159], v[32:39], v8
    v_exp_f32 v42, v42
    v_exp_f32 v43, v43
    v_exp_f32 v44, v44
    s_waitcnt vmcnt(12)
    v_mfma_f32_32x32x16_bf16 v[24:39], v[88:91], v[16:19], 0
    v_exp_f32 v45, v45
    v_exp_f32 v46, v46
    v_exp_f32 v47, v47
    v_exp_f32 v48, v48
    v_exp_f32 v49, v49
    v_smfmac_f32_32x32x32_bf16 v[72:87], v[152:155], v[40:47], v8
    v_exp_f32 v50, v50
    v_exp_f32 v51, v51
    s_sub_u32 s80, s80, 1
    s_cmp_lg_u32 s80, 0
    v_exp_f32 v52, v52
    v_exp_f32 v53, v53
    v_exp_f32 v54, v54
    v_exp_f32 v55, v55
    s_cbranch_scc1 L_attn
    s_add_u32 s101, s101, 1
    s_cmp_eq_u32 s101, 1
    s_cbranch_scc1 L_attn_s0
    s_cmp_eq_u32 s101, 2
    s_cbranch_scc1 L_attn_s1
    s_cmp_eq_u32 s101, 3
    s_cbranch_scc1 L_attn_s2
    v_exp_f32 v24, v24
    v_exp_f32 v25, v25
    v_smfmac_f32_32x32x32_bf16 v[72:87], v[156:159], v[48:55], v8
    v_exp_f32 v26, v26
    v_exp_f32 v27, v27
    v_exp_f32 v28, v28
    v_mfma_f32_32x32x16_bf16 v[40:55], v[88:91], v[20:23], 0
    v_exp_f32 v29, v29
    v_exp_f32 v30, v30
    v_exp_f32 v31, v31
    v_exp_f32 v32, v32
    v_exp_f32 v33, v33
    v_smfmac_f32_32x32x32_bf16 v[56:71], v[92:95], v[24:31], v8
    v_exp_f32 v34, v34
    v_exp_f32 v35, v35
    buffer_load_dwordx4 v[148:151], v15, s[28:31], s81 offen offset:2048 sc1
    s_mov_b64 exec, s[84:85]
    buffer_load_dwordx4 v[152:155], v14, s[28:31], s81 offen offset:3072 sc1
    buffer_load_dwordx4 v[156:159], v14, s[28:31], s81 offen offset:3584 sc1
    s_mov_b64 exec, -1
    s_add_u32 s81, s81, 4096
    s_and_b32 s81, s81, 0x1ffff
    s_cmp_eq_u32 s81, s62
    s_cselect_b32 s81, s63, s81
    v_exp_f32 v36, v36
    v_exp_f32 v37, v37
    v_exp_f32 v38, v38
    v_exp_f32 v39, v39
    v_exp_f32 v40, v40
    v_exp_f32 v41, v41
    v_smfmac_f32_32x32x32_bf16 v[56:71], v[96:99], v[32:39], v8
    v_exp_f32 v42, v42
    v_exp_f32 v43, v43
    v_exp_f32 v44, v44
    s_waitcnt vmcnt(12)
    v_mfma_f32_32x32x16_bf16 v[24:39], v[100:103], v[16:19], 0
    v_exp_f32 v45, v45
    v_exp_f32 v46, v46
    v_exp_f32 v47, v47
    v_exp_f32 v48, v48
    v_exp_f32 v49, v49
    v_smfmac_f32_32x32x32_bf16 v[72:87], v[92:95], v[40:47], v8
    v_exp_f32 v50, v50
    v_exp_f32 v51, v51
    v_exp_f32 v52, v52
    v_exp_f32 v53, v53
    v_exp_f32 v54, v54
    v_exp_f32 v55, v55
    v_exp_f32 v24, v24
    v_exp_f32 v25, v25
    v_smfmac_f32_32x32x32_bf16 v[72:87], v[96:99], v[48:55], v8
    v_exp_f32 v26, v26
    v_exp_f32 v27, v27
    v_exp_f32 v28, v28
    v_mfma_f32_32x32x16_bf16 v[40:55], v[100:103], v[20:23], 0
    v_exp_f32 v29, v29
    v_exp_f32 v30, v30
    v_exp_f32 v31, v31
    v_exp_f32 v32, v32
    v_exp_f32 v33, v33
    v_smfmac_f32_32x32x32_bf16 v[56:71], v[104:107], v[24:31], v8
    v_exp_f32 v34, v34
    v_exp_f32 v35, v35
    v_exp_f32 v36, v36
    v_exp_f32 v37, v37
    v_exp_f32 v38, v38
    v_exp_f32 v39, v39
    v_exp_f32 v40, v40
    v_exp_f32 v41, v41
    v_smfmac_f32_32x32x32_bf16 v[56:71], v[108:111], v[32:39], v8
    v_exp_f32 v42, v42
    v_exp_f32 v43, v43
    v_exp_f32 v44, v44
    s_waitcnt vmcnt(9)
    v_mfma_f32_32x32x16_bf16 v[24:39], v[112:115], v[16:19], 0
    v_exp_f32 v45, v45
    v_exp_f32 v46, v46
    v_exp_f32 v47, v47
    v_exp_f32 v48, v48
    v_exp_f32 v49, v49
    v_smfmac_f32_32x32x32_bf16 v[72:87], v[104:107], v[40:47], v8
    v_exp_f32 v50, v50
    v_exp_f32 v51, v51
    v_exp_f32 v52, v52
    v_exp_f32 v53, v53
    v_exp_f32 v54, v54
    v_exp_f32 v55, v55
    v_exp_f32 v24, v24
    v_exp_f32 v25, v25
    v_smfmac_f32_32x32x32_bf16 v[72:87], v[108:111], v[48:55], v8
    v_exp_f32 v26, v26
    v_exp_f32 v27, v27
    v_exp_f32 v28, v28
    v_mfma_f32_32x32x16_bf16 v[40:55], v[112:115], v[20:23], 0
    v_exp_f32 v29, v29
    v_exp_f32 v30, v30
    v_exp_f32 v31, v31
    v_exp_f32 v32, v32
    v_exp_f32 v33, v33
    v_smfmac_f32_32x32x32_bf16 v[56:71], v[116:119], v[24:31], v8
    v_exp_f32 v34, v34
    v_exp_f32 v35, v35
    v_exp_f32 v36, v36
    v_exp_f32 v37, v37
    v_exp_f32 v38, v38
    v_exp_f32 v39, v39
    v_exp_f32 v40, v40
    v_exp_f32 v41, v41
    v_smfmac_f32_32x32x32_bf16 v[56:71], v[120:123], v[32:39], v8
    v_exp_f32 v42, v42
    v_exp_f32 v43, v43
    v_exp_f32 v44, v44
    s_waitcnt vmcnt(6)
    v_mfma_f32_32x32x16_bf16 v[24:39], v[124:127], v[16:19], 0
    v_exp_f32 v45, v45
    v_exp_f32 v46, v46
    v_exp_f32 v47, v47
    v_exp_f32 v48, v48
    v_exp_f32 v49, v49
    v_smfmac_f32_32x32x32_bf16 v[72:87], v[116:119], v[40:47], v8
    v_exp_f32 v50, v50
    v_exp_f32 v51, v51
    v_exp_f32 v52, v52
    v_exp_f32 v53, v53
    v_exp_f32 v54, v54
    v_exp_f32 v55, v55
    v_exp_f32 v24, v24
    v_exp_f32 v25, v25
    v_smfmac_f32_32x32x32_bf16 v[72:87], v[120:123], v[48:55], v8
    v_exp_f32 v26, v26
    v_exp_f32 v27, v27
    v_exp_f32 v28, v28
    v_mfma_f32_32x32x16_bf16 v[40:55], v[124:127], v[20:23], 0
    v_exp_f32 v29, v29
    v_exp_f32 v30, v30
    v_exp_f32 v31, v31
    v_exp_f32 v32, v32
    v_exp_f32 v33, v33
    v_smfmac_f32_32x32x32_bf16 v[56:71], v[128:131], v[24:31], v8
    v_exp_f32 v34, v34
    v_exp_f32 v35, v35
    v_exp_f32 v36, v36
    v_exp_f32 v37, v37
    v_exp_f32 v38, v38
    v_exp_f32 v39, v39
    v_exp_f32 v40, v40
    v_exp_f32 v41, v41
    v_smfmac_f32_32x32x32_bf16 v[56:71], v[132:135], v[32:39], v8
    v_exp_f32 v42, v42
    v_exp_f32 v43, v43
    v_exp_f32 v44, v44
    s_waitcnt vmcnt(3)
    v_mfma_f32_32x32x16_bf16 v[24:39], v[136:139], v[16:19], 0
    v_exp_f32 v45, v45
    v_exp_f32 v46, v46
    v_exp_f32 v47, v47
    v_exp_f32 v48, v48
    v_exp_f32 v49, v49
    v_smfmac_f32_32x32x32_bf16 v[72:87], v[128:131], v[40:47], v8
    v_exp_f32 v50, v50
    v_exp_f32 v51, v51
    v_exp_f32 v52, v52
    v_exp_f32 v53, v53
    v_exp_f32 v54, v54
    v_exp_f32 v55, v55
    s_setprio 0
    v_exp_f32 v24, v24
    v_exp_f32 v25, v25
    v_smfmac_f32_32x32x32_bf16 v[72:87], v[132:135], v[48:55], v8
    v_exp_f32 v26, v26
    v_exp_f32 v27, v27
    v_exp_f32 v28, v28
    v_mfma_f32_32x32x16_bf16 v[40:55], v[136:139], v[20:23], 0
    v_exp_f32 v29, v29
    v_exp_f32 v30, v30
    v_exp_f32 v31, v31
    v_exp_f32 v32, v32
    v_exp_f32 v33, v33
    v_smfmac_f32_32x32x32_bf16 v[56:71], v[140:143], v[24:31], v8
    v_exp_f32 v34, v34
    v_exp_f32 v35, v35
    v_exp_f32 v36, v36
    v_exp_f32 v37, v37
    v_exp_f32 v38, v38
    v_exp_f32 v39, v39
    v_exp_f32 v40, v40
    v_exp_f32 v41, v41
    v_smfmac_f32_32x32x32_bf16 v[56:71], v[144:147], v[32:39], v8
    v_exp_f32 v42, v42
    v_exp_f32 v43, v43
    v_exp_f32 v44, v44
    s_waitcnt vmcnt(0)
    v_mfma_f32_32x32x16_bf16 v[24:39], v[148:151], v[16:19], 0
    v_exp_f32 v45, v45
    v_exp_f32 v46, v46
    v_exp_f32 v47, v47
    v_exp_f32 v48, v48
    v_exp_f32 v49, v49
    v_smfmac_f32_32x32x32_bf16 v[72:87], v[140:143], v[40:47], v8
    v_exp_f32 v50, v50
    v_exp_f32 v51, v51
    v_exp_f32 v52, v52
    v_exp_f32 v53, v53
    v_exp_f32 v54, v54
    v_exp_f32 v55, v55
    v_exp_f32 v24, v24
    v_exp_f32 v25, v25
    v_smfmac_f32_32x32x32_bf16 v[72:87], v[144:147], v[48:55], v8
    v_exp_f32 v26, v26
    v_exp_f32 v27, v27
    v_exp_f32 v28, v28
    v_mfma_f32_32x32x16_bf16 v[40:55], v[148:151], v[20:23], 0
    v_exp_f32 v29, v29
    v_exp_f32 v30, v30
    v_exp_f32 v31, v31
    v_exp_f32 v32, v32
    v_exp_f32 v33, v33
    v_smfmac_f32_32x32x32_bf16 v[56:71], v[152:155], v[24:31], v8
    v_exp_f32 v34, v34
    v_exp_f32 v35, v35
    v_exp_f32 v36, v36
    v_exp_f32 v37, v37
    v_exp_f32 v38, v38
    v_exp_f32 v39, v39
    v_exp_f32 v40, v40
    v_exp_f32 v41, v41
    v_smfmac_f32_32x32x32_bf16 v[56:71], v[156:159], v[32:39], v8
    v_exp_f32 v42, v42
    v_exp_f32 v43, v43
    v_exp_f32 v44, v44
    v_exp_f32 v45, v45
    v_exp_f32 v46, v46
    v_exp_f32 v47, v47
    v_exp_f32 v48, v48
    v_exp_f32 v49, v49
    v_smfmac_f32_32x32x32_bf16 v[72:87], v[152:155], v[40:47], v8
    v_exp_f32 v50, v50
    v_exp_f32 v51, v51
    s_lshl_b32 s74, s3, 11
    v_add_u32 v10, s74, v246
    s_lshl_b32 s74, s3, 8
    v_add_u32 v11, s74, v249
    ds_write_b32 v11, v64 offset:16384
    ds_write_b128 v10, v[56:59] offset:0
    ds_write_b128 v10, v[60:63] offset:1024
    v_exp_f32 v52, v52
    v_exp_f32 v53, v53
    v_exp_f32 v54, v54
    v_exp_f32 v55, v55
    s_nop 1
    v_smfmac_f32_32x32x32_bf16 v[72:87], v[156:159], v[48:55], v8
    s_setprio 0
L_attn_end:
    v_xor_b32 v10, 8192, v10
    v_xor_b32 v11, 1024, v11
    s_waitcnt lgkmcnt(0)
    s_barrier
    ds_read_b32 v32, v11 offset:16384
    ds_read_b128 v[24:27], v10 offset:0
    ds_read_b128 v[28:31], v10 offset:1024
    v_mov_b32 v40, 0x1f800000
    v_mov_b32 v41, 0x5f800000
    v_mov_b32 v44, 0
    v_mov_b32 v45, 0
    v_mov_b32 v47, 0
    s_waitcnt lgkmcnt(2)
    v_add_f32 v80, v80, v32
    v_mov_b32 v46, v80
    s_waitcnt lgkmcnt(0)
    v_pk_add_f32 v[72:73], v[72:73], v[24:25]
    v_pk_add_f32 v[74:75], v[74:75], v[26:27]
    v_pk_add_f32 v[76:77], v[76:77], v[28:29]
    v_pk_add_f32 v[78:79], v[78:79], v[30:31]
    v_pk_fma_f32 v[46:47], v[72:73], v[44:45], v[46:47]
    v_pk_fma_f32 v[46:47], v[74:75], v[44:45], v[46:47]
    v_pk_fma_f32 v[46:47], v[76:77], v[44:45], v[46:47]
    v_pk_fma_f32 v[46:47], v[78:79], v[44:45], v[46:47]
    v_add_f32 v46, v46, v47
    v_cmp_ge_f32 vcc, v46, v40
    v_cmp_le_f32 s[94:95], v46, v41
    v_rcp_f32 v10, v80
    s_and_b64 vcc, vcc, s[94:95]
    s_cmp_eq_u64 vcc, -1
    s_cbranch_scc0 L_attn_fb
L_attn_fin:
    v_mov_b32 v11, v10
    v_pk_mul_f32 v[72:73], v[72:73], v[10:11]
    v_pk_mul_f32 v[74:75], v[74:75], v[10:11]
    v_pk_mul_f32 v[76:77], v[76:77], v[10:11]
    v_pk_mul_f32 v[78:79], v[78:79], v[10:11]
    v_cvt_pk_bf16_f32 v24, v72, v73
    v_cvt_pk_bf16_f32 v25, v74, v75
    v_cvt_pk_bf16_f32 v26, v76, v77
    v_cvt_pk_bf16_f32 v27, v78, v79
    buffer_store_dwordx4 v[24:27], v246, s[28:31], s82 offen sc1
    s_cmp_lt_u32 s3, 4
    s_cbranch_scc1 L_p3_a
    ds_read_b64_tr_b16 v[64:65], v5 offset:0
    ds_read_b64_tr_b16 v[66:67], v5 offset:512
    ds_read_b64_tr_b16 v[68:69], v5 offset:2048
    ds_read_b64_tr_b16 v[70:71], v5 offset:2560
    ds_read_b64_tr_b16 v[72:73], v5 offset:4096
    ds_read_b64_tr_b16 v[74:75], v5 offset:4608
    ds_read_b64_tr_b16 v[76:77], v5 offset:6144
    ds_read_b64_tr_b16 v[78:79], v5 offset:6656
    ds_read_b64_tr_b16 v[80:81], v5 offset:8192
    ds_read_b64_tr_b16 v[82:83], v5 offset:8704
    ds_read_b64_tr_b16 v[84:85], v5 offset:10240
    ds_read_b64_tr_b16 v[86:87], v5 offset:10752
    ds_read_b64_tr_b16 v[88:89], v5 offset:12288
    ds_read_b64_tr_b16 v[90:91], v5 offset:12800
    ds_read_b64_tr_b16 v[92:93], v5 offset:14336
    ds_read_b64_tr_b16 v[94:95], v5 offset:14848
    ds_read_b64_tr_b16 v[96:97], v6 offset:0
    ds_read_b64_tr_b16 v[98:99], v6 offset:512
    ds_read_b64_tr_b16 v[100:101], v6 offset:2048
    ds_read_b64_tr_b16 v[102:103], v6 offset:2560
    ds_read_b64_tr_b16 v[104:105], v6 offset:4096
    ds_read_b64_tr_b16 v[106:107], v6 offset:4608
    ds_read_b64_tr_b16 v[108:109], v6 offset:6144
    ds_read_b64_tr_b16 v[110:111], v6 offset:6656
    ds_read_b64_tr_b16 v[112:113], v6 offset:8192
    ds_read_b64_tr_b16 v[114:115], v6 offset:8704
    ds_read_b64_tr_b16 v[116:117], v6 offset:10240
    ds_read_b64_tr_b16 v[118:119], v6 offset:10752
    ds_read_b64_tr_b16 v[120:121], v6 offset:12288
    ds_read_b64_tr_b16 v[122:123], v6 offset:12800
    ds_read_b64_tr_b16 v[124:125], v6 offset:14336
    ds_read_b64_tr_b16 v[126:127], v6 offset:14848
    ds_read_b64_tr_b16 v[128:129], v6 offset:16384
    ds_read_b64_tr_b16 v[130:131], v6 offset:16896
    ds_read_b64_tr_b16 v[132:133], v6 offset:18432
    ds_read_b64_tr_b16 v[134:135], v6 offset:18944
    ds_read_b64_tr_b16 v[136:137], v6 offset:20480
    ds_read_b64_tr_b16 v[138:139], v6 offset:20992
    s_and_b32 s97, s3, 3
    s_mul_i32 s72, s97, 88064
    s_lshl_b32 s97, s97, 12
    s_add_u32 s86, s72, 0
    s_add_u32 s87, s72, 352256
    s_add_u32 s88, s72, 704512
    s_add_u32 s89, s72, 1056768
    s_waitcnt vmcnt(0) lgkmcnt(0)
    s_mov_b32 exec_lo, 0x01010101
    s_mov_b32 exec_hi, 0x01010101
    buffer_load_dword v251, v246, s[28:31], s82 offen sc1
    s_mov_b64 exec, -1
    s_barrier
    s_add_u32 m0, s97, 131072
    s_add_u32 s79, s86, 128
    buffer_load_dwordx4 v13, s[20:23], s79 offen  lds
    s_add_u32 m0, s97, 132096
    s_add_u32 s79, s86, 22144
    buffer_load_dwordx4 v13, s[20:23], s79 offen  lds
    s_add_u32 m0, s97, 133120
    s_add_u32 s79, s86, 44160
    buffer_load_dwordx4 v13, s[20:23], s79 offen  lds
    s_add_u32 m0, s97, 134144
    s_add_u32 s79, s86, 66176
    buffer_load_dwordx4 v13, s[20:23], s79 offen  lds
    s_add_u32 m0, s97, 147456
    s_add_u32 s79, s87, 128
    buffer_load_dwordx4 v13, s[20:23], s79 offen  lds
    s_add_u32 m0, s97, 148480
    s_add_u32 s79, s87, 22144
    buffer_load_dwordx4 v13, s[20:23], s79 offen  lds
    s_add_u32 m0, s97, 149504
    s_add_u32 s79, s87, 44160
    buffer_load_dwordx4 v13, s[20:23], s79 offen  lds
    s_add_u32 m0, s97, 150528
    s_add_u32 s79, s87, 66176
    buffer_load_dwordx4 v13, s[20:23], s79 offen  lds
    s_and_b32 s72, s3, 3
    s_lshl_b32 s75, s72, 10
    s_lshl_b32 s72, s72, 10
    s_add_u32 s72, s72, s60
    s_add_u32 s76, s72, 6291456
    s_and_b32 s72, s3, 2
    s_lshl_b32 s72, s72, 12
    v_add_u32 v4, s72, v246
    v_add_u32 v5, 65536, v4
    v_add_u32 v6, 131072, v4
    s_and_b32 s79, s2, 1
    s_lshl_b32 s79, s79, 12
    s_sub_u32 s72, s76, s79
    s_add_u32 s76, s76, s79
    s_add_u32 s99, s60, 6946816
    s_lshl_b32 s79, s69, 2
    s_add_u32 s98, s60, s79
    s_add_u32 s98, s98, 6946816
    s_barrier
    s_add_u32 m0, s75, 0
    s_add_u32 s79, s76, 0
    buffer_load_dwordx4 v246, s[28:31], s79 offen sc1 lds
    s_add_u32 m0, s75, 4096
    s_add_u32 s79, s76, 65536
    buffer_load_dwordx4 v246, s[28:31], s79 offen sc1 lds
    s_add_u32 m0, s75, 8192
    s_add_u32 s79, s76, 32768
    buffer_load_dwordx4 v246, s[28:31], s79 offen sc1 lds
    s_add_u32 m0, s75, 12288
    s_add_u32 s79, s76, 98304
    buffer_load_dwordx4 v246, s[28:31], s79 offen sc1 lds
    s_add_u32 m0, s75, 16384
    s_add_u32 s79, s72, 4096
    buffer_load_dwordx4 v246, s[28:31], s79 offen sc1 lds
    s_add_u32 m0, s75, 20480
    s_add_u32 s79, s72, 69632
    buffer_load_dwordx4 v246, s[28:31], s79 offen sc1 lds
    s_add_u32 m0, s75, 24576
    s_add_u32 s79, s72, 36864
    buffer_load_dwordx4 v246, s[28:31], s79 offen sc1 lds
    s_add_u32 m0, s75, 28672
    s_add_u32 s79, s72, 102400
    buffer_load_dwordx4 v246, s[28:31], s79 offen sc1 lds
    s_add_u32 m0, s75, 32768
    s_add_u32 s79, s76, 16384
    buffer_load_dwordx4 v246, s[28:31], s79 offen sc1 lds
    s_add_u32 m0, s75, 36864
    s_add_u32 s79, s76, 81920
    buffer_load_dwordx4 v246, s[28:31], s79 offen sc1 lds
    s_add_u32 m0, s75, 40960
    s_add_u32 s79, s76, 49152
    buffer_load_dwordx4 v246, s[28:31], s79 offen sc1 lds
    s_add_u32 m0, s75, 45056
    s_add_u32 s79, s76, 114688
    buffer_load_dwordx4 v246, s[28:31], s79 offen sc1 lds
    s_waitcnt vmcnt(8)
    s_barrier
    s_add_u32 m0, s75, 49152
    s_add_u32 s79, s72, 20480
    buffer_load_dwordx4 v246, s[28:31], s79 offen sc1 lds
    s_add_u32 m0, s75, 53248
    s_add_u32 s79, s72, 86016
    buffer_load_dwordx4 v246, s[28:31], s79 offen sc1 lds
    s_add_u32 m0, s75, 57344
    s_add_u32 s79, s72, 53248
    buffer_load_dwordx4 v246, s[28:31], s79 offen sc1 lds
    s_add_u32 m0, s75, 61440
    s_add_u32 s79, s72, 118784
    buffer_load_dwordx4 v246, s[28:31], s79 offen sc1 lds
    s_waitcnt vmcnt(8)
    s_barrier
    s_waitcnt vmcnt(4)
    s_barrier
    s_waitcnt vmcnt(0)
    s_barrier
    v_lshlrev_b32 v32, 16, v252
    v_and_b32 v33, 0xffff0000, v252
    v_lshlrev_b32 v34, 16, v253
    v_and_b32 v35, 0xffff0000, v253
    v_lshlrev_b32 v36, 16, v254
    v_and_b32 v37, 0xffff0000, v254
    v_lshlrev_b32 v38, 16, v255
    v_and_b32 v39, 0xffff0000, v255
    v_mov_b32 v10, 0x3f803f80
    v_and_b32 v7, 0x1f8, v0
    s_lshl_b32 s74, s3, 6
    s_add_u32 s74, s74, s69
    s_lshl_b32 s74, s74, 7
    s_add_u32 s74, s74, s60
    s_add_u32 s74, s74, 6422528
    s_add_u32 s77, s60, 6950912
    s_lshl_b32 s78, s69, 9
    s_add_u32 s78, s78, s77
    s_barrier
    ds_read_b128 v[16:19], v244
    ds_read_b128 v[24:27], v244 offset:16384
    ds_read_b128 v[20:23], v245
    ds_read_b128 v[28:31], v245 offset:16384
    s_waitcnt lgkmcnt(2)
    v_pk_add_f32 v[32:33], v[32:33], v[16:17]
    v_pk_add_f32 v[32:33], v[32:33], v[24:25]
    v_pk_add_f32 v[34:35], v[34:35], v[18:19]
    v_pk_add_f32 v[34:35], v[34:35], v[26:27]
    v_cvt_pk_bf16_f32 v252, v32, v33
    v_cvt_pk_bf16_f32 v253, v34, v35
    s_waitcnt lgkmcnt(0)
    v_pk_add_f32 v[36:37], v[36:37], v[20:21]
    v_pk_add_f32 v[36:37], v[36:37], v[28:29]
    v_pk_add_f32 v[38:39], v[38:39], v[22:23]
    v_pk_add_f32 v[38:39], v[38:39], v[30:31]
    v_cvt_pk_bf16_f32 v254, v36, v37
    v_cvt_pk_bf16_f32 v255, v38, v39
    s_branch L_p3_done
L_p3_a:
    s_cmp_lt_u32 s2, 176
    s_cselect_b32 s101, s3, 0
    s_cmp_lg_u32 s101, 1
    s_cbranch_scc1 L_cs_noload
    v_lshrrev_b32 v10, 3, v1
    v_mul_u32_u24 v10, 2752, v10
    v_and_b32 v11, 7, v1
    v_lshl_add_u32 v10, v11, 4, v10
    s_and_b32 s72, s2, 7
    s_mul_i32 s72, s72, 176128
    s_lshr_b32 s73, s2, 3
    s_lshl_b32 s73, s73, 7
    s_add_u32 s72, s72, s73
    buffer_load_dwordx4 v[28:31], v10, s[20:23], s72 offen
    s_add_u32 s72, s72, 22016
    buffer_load_dwordx4 v[32:35], v10, s[20:23], s72 offen
    s_add_u32 s72, s72, 22016
    buffer_load_dwordx4 v[36:39], v10, s[20:23], s72 offen
    s_add_u32 s72, s72, 22016
    buffer_load_dwordx4 v[40:43], v10, s[20:23], s72 offen
    s_add_u32 s72, s72, 22016
    buffer_load_dwordx4 v[44:47], v10, s[20:23], s72 offen
    s_add_u32 s72, s72, 22016
    buffer_load_dwordx4 v[48:51], v10, s[20:23], s72 offen
    s_add_u32 s72, s72, 22016
    buffer_load_dwordx4 v[52:55], v10, s[20:23], s72 offen
    s_add_u32 s72, s72, 22016
    buffer_load_dwordx4 v[56:59], v10, s[20:23], s72 offen
    s_add_u32 s72, s72, 22016
L_cs_noload:
    s_add_u32 s99, s60, 6946816
    s_lshl_b32 s79, s66, 2
    s_add_u32 s98, s61, s79
    s_add_u32 s98, s98, 6946816
    s_bfe_u32 s72, s3, 0x10001
    v_bfe_u32 v10, v1, 2, 2
    v_lshrrev_b32 v11, 1, v10
    v_xor_b32 v11, s72, v11
    v_lshlrev_b32 v11, 6, v11
    v_lshl_add_u32 v11, v10, 7, v11
    v_bfe_u32 v10, v1, 4, 1
    v_lshl_add_u32 v11, v10, 5, v11
    v_and_b32 v10, 1, v1
    v_lshl_add_u32 v11, v10, 4, v11
    v_bfe_u32 v10, v1, 1, 1
    v_lshl_add_u32 v11, v10, 3, v11
    v_lshrrev_b32 v10, 5, v1
    v_lshl_add_u32 v8, v10, 10, v11
    v_add_u32 v8, 65536, v8
    v_add_u32 v9, 49152, v8
    s_and_b32 s72, s3, 3
    s_lshl_b32 s75, s72, 10
    s_lshl_b32 s72, s72, 10
    s_add_u32 s72, s72, s60
    s_add_u32 s76, s72, 6291456
    s_and_b32 s72, s3, 2
    s_lshl_b32 s72, s72, 12
    v_add_u32 v4, s72, v246
    v_add_u32 v5, 65536, v4
    v_add_u32 v6, 131072, v4
    s_cmp_eq_u32 s101, 1
    s_waitcnt vmcnt(8)
    s_cbranch_scc1 L_cs_loaded
    s_waitcnt vmcnt(0)
L_cs_loaded:
    s_mov_b32 exec_lo, 0x01010101
    s_mov_b32 exec_hi, 0x01010101
    buffer_load_dword v251, v246, s[28:31], s82 offen sc1
    s_mov_b64 exec, -1
    s_barrier
    s_cmp_lg_u32 s3, 0
    s_cbranch_scc1 L_nf_15
    s_mov_b64 exec, 1
    buffer_store_dword v248, v249, s[28:31], s98 offen offset:0 sc1
    s_mov_b64 exec, -1
L_nf_15:
    ds_read_b64_tr_b16 v[64:65], v8 offset:0
    ds_read_b64_tr_b16 v[66:67], v8 offset:512
    ds_read_b64_tr_b16 v[68:69], v8 offset:2048
    ds_read_b64_tr_b16 v[70:71], v8 offset:2560
    ds_read_b64_tr_b16 v[72:73], v8 offset:4096
    ds_read_b64_tr_b16 v[74:75], v8 offset:4608
    ds_read_b64_tr_b16 v[76:77], v8 offset:6144
    ds_read_b64_tr_b16 v[78:79], v8 offset:6656
    ds_read_b64_tr_b16 v[80:81], v8 offset:8192
    ds_read_b64_tr_b16 v[82:83], v8 offset:8704
    ds_read_b64_tr_b16 v[84:85], v8 offset:10240
    ds_read_b64_tr_b16 v[86:87], v8 offset:10752
    ds_read_b64_tr_b16 v[88:89], v8 offset:12288
    ds_read_b64_tr_b16 v[90:91], v8 offset:12800
    ds_read_b64_tr_b16 v[92:93], v8 offset:14336
    ds_read_b64_tr_b16 v[94:95], v8 offset:14848
    ds_read_b64_tr_b16 v[96:97], v8 offset:16384
    ds_read_b64_tr_b16 v[98:99], v8 offset:16896
    ds_read_b64_tr_b16 v[100:101], v8 offset:18432
    ds_read_b64_tr_b16 v[102:103], v8 offset:18944
    ds_read_b64_tr_b16 v[104:105], v8 offset:20480
    ds_read_b64_tr_b16 v[106:107], v8 offset:20992
    ds_read_b64_tr_b16 v[108:109], v8 offset:22528
    ds_read_b64_tr_b16 v[110:111], v8 offset:23040
    ds_read_b64_tr_b16 v[112:113], v8 offset:24576
    ds_read_b64_tr_b16 v[114:115], v8 offset:25088
    ds_read_b64_tr_b16 v[116:117], v8 offset:26624
    ds_read_b64_tr_b16 v[118:119], v8 offset:27136
    ds_read_b64_tr_b16 v[120:121], v8 offset:28672
    ds_read_b64_tr_b16 v[122:123], v8 offset:29184
    ds_read_b64_tr_b16 v[124:125], v8 offset:30720
    ds_read_b64_tr_b16 v[126:127], v8 offset:31232
    ds_read_b64_tr_b16 v[128:129], v8 offset:32768
    ds_read_b64_tr_b16 v[130:131], v8 offset:33280
    ds_read_b64_tr_b16 v[132:133], v8 offset:34816
    ds_read_b64_tr_b16 v[134:135], v8 offset:35328
    ds_read_b64_tr_b16 v[136:137], v8 offset:36864
    ds_read_b64_tr_b16 v[138:139], v8 offset:37376
    ds_read_b64_tr_b16 v[140:141], v8 offset:38912
    ds_read_b64_tr_b16 v[142:143], v8 offset:39424
    ds_read_b64_tr_b16 v[144:145], v8 offset:40960
    ds_read_b64_tr_b16 v[146:147], v8 offset:41472
    ds_read_b64_tr_b16 v[148:149], v8 offset:43008
    ds_read_b64_tr_b16 v[150:151], v8 offset:43520
    ds_read_b64_tr_b16 v[152:153], v8 offset:45056
    ds_read_b64_tr_b16 v[154:155], v8 offset:45568
    ds_read_b64_tr_b16 v[156:157], v8 offset:47104
    ds_read_b64_tr_b16 v[158:159], v8 offset:47616
    s_cmp_lg_u32 s101, 1
    s_cbranch_scc1 L_cs_nojob
    v_mov_b32 v10, 0x00003f80
    v_mov_b32 v11, 0x3f800000
    s_waitcnt vmcnt(8)
    v_dot2_f32_bf16 v16, v28, v10, 0
    v_dot2_f32_bf16 v17, v28, v11, 0
    v_dot2_f32_bf16 v18, v29, v10, 0
    v_dot2_f32_bf16 v19, v29, v11, 0
    v_dot2_f32_bf16 v20, v30, v10, 0
    v_dot2_f32_bf16 v21, v30, v11, 0
    v_dot2_f32_bf16 v22, v31, v10, 0
    v_dot2_f32_bf16 v23, v31, v11, 0
    s_waitcnt vmcnt(7)
    v_dot2_f32_bf16 v16, v32, v10, v16
    v_dot2_f32_bf16 v17, v32, v11, v17
    v_dot2_f32_bf16 v18, v33, v10, v18
    v_dot2_f32_bf16 v19, v33, v11, v19
    v_dot2_f32_bf16 v20, v34, v10, v20
    v_dot2_f32_bf16 v21, v34, v11, v21
    v_dot2_f32_bf16 v22, v35, v10, v22
    v_dot2_f32_bf16 v23, v35, v11, v23
    s_waitcnt vmcnt(6)
    v_dot2_f32_bf16 v16, v36, v10, v16
    v_dot2_f32_bf16 v17, v36, v11, v17
    v_dot2_f32_bf16 v18, v37, v10, v18
    v_dot2_f32_bf16 v19, v37, v11, v19
    v_dot2_f32_bf16 v20, v38, v10, v20
    v_dot2_f32_bf16 v21, v38, v11, v21
    v_dot2_f32_bf16 v22, v39, v10, v22
    v_dot2_f32_bf16 v23, v39, v11, v23
    s_waitcnt vmcnt(5)
    v_dot2_f32_bf16 v16, v40, v10, v16
    v_dot2_f32_bf16 v17, v40, v11, v17
    v_dot2_f32_bf16 v18, v41, v10, v18
    v_dot2_f32_bf16 v19, v41, v11, v19
    v_dot2_f32_bf16 v20, v42, v10, v20
    v_dot2_f32_bf16 v21, v42, v11, v21
    v_dot2_f32_bf16 v22, v43, v10, v22
    v_dot2_f32_bf16 v23, v43, v11, v23
    s_waitcnt vmcnt(4)
    v_dot2_f32_bf16 v16, v44, v10, v16
    v_dot2_f32_bf16 v17, v44, v11, v17
    v_dot2_f32_bf16 v18, v45, v10, v18
    v_dot2_f32_bf16 v19, v45, v11, v19
    v_dot2_f32_bf16 v20, v46, v10, v20
    v_dot2_f32_bf16 v21, v46, v11, v21
    v_dot2_f32_bf16 v22, v47, v10, v22
    v_dot2_f32_bf16 v23, v47, v11, v23
    s_waitcnt vmcnt(3)
    v_dot2_f32_bf16 v16, v48, v10, v16
    v_dot2_f32_bf16 v17, v48, v11, v17
    v_dot2_f32_bf16 v18, v49, v10, v18
    v_dot2_f32_bf16 v19, v49, v11, v19
    v_dot2_f32_bf16 v20, v50, v10, v20
    v_dot2_f32_bf16 v21, v50, v11, v21
    v_dot2_f32_bf16 v22, v51, v10, v22
    v_dot2_f32_bf16 v23, v51, v11, v23
    s_waitcnt vmcnt(2)
    v_dot2_f32_bf16 v16, v52, v10, v16
    v_dot2_f32_bf16 v17, v52, v11, v17
    v_dot2_f32_bf16 v18, v53, v10, v18
    v_dot2_f32_bf16 v19, v53, v11, v19
    v_dot2_f32_bf16 v20, v54, v10, v20
    v_dot2_f32_bf16 v21, v54, v11, v21
    v_dot2_f32_bf16 v22, v55, v10, v22
    v_dot2_f32_bf16 v23, v55, v11, v23
    s_waitcnt vmcnt(1)
    v_dot2_f32_bf16 v16, v56, v10, v16
    v_dot2_f32_bf16 v17, v56, v11, v17
    v_dot2_f32_bf16 v18, v57, v10, v18
    v_dot2_f32_bf16 v19, v57, v11, v19
    v_dot2_f32_bf16 v20, v58, v10, v20
    v_dot2_f32_bf16 v21, v58, v11, v21
    v_dot2_f32_bf16 v22, v59, v10, v22
    v_dot2_f32_bf16 v23, v59, v11, v23
    s_and_b32 s72, s2, 7
    s_mul_i32 s72, s72, 5632
    s_lshr_b32 s73, s2, 3
    s_lshl_b32 s73, s73, 8
    v_permlane32_swap_b32 v16, v20
    v_permlane32_swap_b32 v17, v21
    v_permlane32_swap_b32 v18, v22
    v_permlane32_swap_b32 v19, v23
    s_add_u32 s72, s72, s73
    s_add_u32 s72, s72, 393216
    v_add_f32 v16, v16, v20
    v_add_f32 v17, v17, v21
    v_add_f32 v18, v18, v22
    v_add_f32 v19, v19, v23
    s_nop 1
    v_permlane16_swap_b32 v16, v18
    v_permlane16_swap_b32 v17, v19
    s_nop 1
    v_add_f32 v16, v16, v18
    v_add_f32 v17, v17, v19
    v_and_b32 v10, 7, v1
    v_lshrrev_b32 v11, 4, v1
    v_add_f32_dpp v16, v16, v16 row_ror:8 row_mask:0xf bank_mask:0xf
    v_add_f32_dpp v17, v17, v17 row_ror:8 row_mask:0xf bank_mask:0xf
    v_lshlrev_b32 v11, 3, v11
    v_lshl_add_u32 v10, v10, 5, v11
    s_mov_b32 exec_lo, 0x00ff00ff
    s_mov_b32 exec_hi, 0x00ff00ff
    buffer_store_dwordx2 v[16:17], v10, s[28:31], s72 offen sc1
    s_mov_b64 exec, -1
L_cs_nojob:
    s_cmp_lg_u32 s3, 0
    s_cbranch_scc1 L_o_seen
    s_add_u32 s46, s99, 0
    s_load_dwordx8 s[48:55], s[64:65], s46 glc
    s_mov_b32 s44, s70
    s_mov_b32 s45, s70
    s_mov_b32 s47, 0
L_sp_16:
    s_waitcnt lgkmcnt(0)
    s_xor_b64 s[48:49], s[48:49], s[44:45]
    s_xor_b64 s[50:51], s[50:51], s[44:45]
    s_xor_b64 s[52:53], s[52:53], s[44:45]
    s_xor_b64 s[54:55], s[54:55], s[44:45]
    s_or_b64 s[48:49], s[48:49], s[50:51]
    s_or_b64 s[48:49], s[48:49], s[52:53]
    s_or_b64 s[48:49], s[48:49], s[54:55]
    s_cbranch_scc0 L_spok_17
    s_load_dwordx8 s[48:55], s[64:65], s46 glc
    s_add_u32 s47, s47, 1
    s_cmp_lt_u32 s47, 16
    s_cbranch_scc1 L_sp_16
    s_waitcnt lgkmcnt(0)
    v_not_b32 v247, v248
    v_cmp_eq_u32 vcc, v247, v248
    s_nop 0
    s_and_b32 s79, vcc_lo, 0xff
    s_cmp_eq_u32 s79, 0xff
    s_cbranch_scc1 L_skip_18
    s_mov_b32 exec_hi, 0
    s_mov_b32 exec_lo, 0xff
    s_mov_b32 s93, 0
L_poll_19:
    buffer_load_dword v247, v249, s[28:31], s99 offen offset:0 sc1
    s_add_u32 s93, s93, 1
    s_waitcnt vmcnt(0)
    v_cmp_eq_u32 vcc, v247, v248
    s_cmp_gt_u32 s93, 200000
    s_cbranch_scc1 L_done_20
    s_cmp_eq_u64 vcc, exec
    s_cbranch_scc0 L_poll_19
L_done_20:
    s_mov_b64 exec, -1
L_skip_18:
L_spok_17:
L_o_seen:
    s_waitcnt lgkmcnt(0)
    s_barrier
    s_cmp_lg_u32 s101, 1
    s_cbranch_scc1 L_cs_noflag
    s_lshl_b32 s72, s2, 2
    s_add_u32 s72, s72, 32768
    s_waitcnt vmcnt(0)
    s_mov_b64 exec, 1
    buffer_store_dword v248, v249, s[28:31], s72 offen sc1
    s_mov_b64 exec, -1
L_cs_noflag:
    s_or_b32 s72, s2, s3
    s_cbranch_scc1 L_notag
    s_mov_b64 exec, 1
    buffer_store_dword v248, v249, s[28:31], 0 offen offset:0 sc1
    s_mov_b64 exec, -1
L_notag:
    v_lshlrev_b32 v224, 16, v252
    v_and_b32 v225, 0xffff0000, v252
    v_lshlrev_b32 v226, 16, v253
    v_and_b32 v227, 0xffff0000, v253
    v_lshlrev_b32 v228, 16, v254
    v_and_b32 v229, 0xffff0000, v254
    v_lshlrev_b32 v230, 16, v255
    v_and_b32 v231, 0xffff0000, v255
    v_mov_b32 v10, 0x3f803f80
    v_and_b32 v7, 0x1f8, v0
    s_lshl_b32 s74, s3, 6
    s_add_u32 s74, s74, s69
    s_lshl_b32 s74, s74, 7
    s_add_u32 s74, s74, s60
    s_add_u32 s74, s74, 6422528
    s_add_u32 s77, s60, 6950912
    s_lshl_b32 s78, s69, 9
    s_add_u32 s78, s78, s77
    s_barrier
    ds_read_b128 v[48:51], v4 offset:0
    ds_read_b128 v[52:55], v4 offset:4096
    ds_read_b128 v[56:59], v4 offset:1024
    ds_read_b128 v[60:63], v4 offset:5120
    s_waitcnt lgkmcnt(3)
    v_mfma_f32_32x32x16_bf16 v[16:31], v[160:163], v[48:51], 0
    ds_read_b128 v[48:51], v4 offset:2048
    s_waitcnt lgkmcnt(3)
    v_mfma_f32_32x32x16_bf16 v[32:47], v[160:163], v[52:55], 0
    ds_read_b128 v[52:55], v4 offset:6144
    s_waitcnt lgkmcnt(3)
    v_mfma_f32_32x32x16_bf16 v[16:31], v[164:167], v[56:59], v[16:31]
    ds_read_b128 v[56:59], v4 offset:3072
    s_waitcnt lgkmcnt(3)
    v_mfma_f32_32x32x16_bf16 v[32:47], v[164:167], v[60:63], v[32:47]
    ds_read_b128 v[60:63], v4 offset:7168
    s_waitcnt lgkmcnt(3)
    v_mfma_f32_32x32x16_bf16 v[16:31], v[168:171], v[48:51], v[16:31]
    s_barrier
    ds_read_b128 v[48:51], v4 offset:16384
    s_waitcnt lgkmcnt(3)
    v_mfma_f32_32x32x16_bf16 v[32:47], v[168:171], v[52:55], v[32:47]
    ds_read_b128 v[52:55], v4 offset:20480
    s_waitcnt lgkmcnt(3)
    v_mfma_f32_32x32x16_bf16 v[16:31], v[172:175], v[56:59], v[16:31]
    ds_read_b128 v[56:59], v4 offset:17408
    s_waitcnt lgkmcnt(3)
    v_mfma_f32_32x32x16_bf16 v[32:47], v[172:175], v[60:63], v[32:47]
    ds_read_b128 v[60:63], v4 offset:21504
    s_waitcnt lgkmcnt(3)
    v_mfma_f32_32x32x16_bf16 v[16:31], v[176:179], v[48:51], v[16:31]
    ds_read_b128 v[48:51], v4 offset:18432
    s_waitcnt lgkmcnt(3)
    v_mfma_f32_32x32x16_bf16 v[32:47], v[176:179], v[52:55], v[32:47]
    ds_read_b128 v[52:55], v4 offset:22528
    s_waitcnt lgkmcnt(3)
    v_mfma_f32_32x32x16_bf16 v[16:31], v[180:183], v[56:59], v[16:31]
    ds_read_b128 v[56:59], v4 offset:19456
    s_waitcnt lgkmcnt(3)
    v_mfma_f32_32x32x16_bf16 v[32:47], v[180:183], v[60:63], v[32:47]
    ds_read_b128 v[60:63], v4 offset:23552
    s_waitcnt lgkmcnt(3)
    v_mfma_f32_32x32x16_bf16 v[16:31], v[184:187], v[48:51], v[16:31]
    s_barrier
    ds_read_b128 v[48:51], v4 offset:32768
    s_waitcnt lgkmcnt(3)
    v_mfma_f32_32x32x16_bf16 v[32:47], v[184:187], v[52:55], v[32:47]
    ds_read_b128 v[52:55], v4 offset:36864
    s_waitcnt lgkmcnt(3)
    v_mfma_f32_32x32x16_bf16 v[16:31], v[188:191], v[56:59], v[16:31]
    ds_read_b128 v[56:59], v4 offset:33792
    s_waitcnt lgkmcnt(3)
    v_mfma_f32_32x32x16_bf16 v[32:47], v[188:191], v[60:63], v[32:47]
    ds_read_b128 v[60:63], v4 offset:37888
    s_waitcnt lgkmcnt(3)
    v_mfma_f32_32x32x16_bf16 v[16:31], v[192:195], v[48:51], v[16:31]
    ds_read_b128 v[48:51], v4 offset:34816
    s_waitcnt lgkmcnt(3)
    v_mfma_f32_32x32x16_bf16 v[32:47], v[192:195], v[52:55], v[32:47]
    ds_read_b128 v[52:55], v4 offset:38912
    s_waitcnt lgkmcnt(3)
    v_mfma_f32_32x32x16_bf16 v[16:31], v[196:199], v[56:59], v[16:31]
    ds_read_b128 v[56:59], v4 offset:35840
    s_waitcnt lgkmcnt(3)
    v_mfma_f32_32x32x16_bf16 v[32:47], v[196:199], v[60:63], v[32:47]
    ds_read_b128 v[60:63], v4 offset:39936
    s_waitcnt lgkmcnt(3)
    v_mfma_f32_32x32x16_bf16 v[16:31], v[200:203], v[48:51], v[16:31]
    s_barrier
    ds_read_b128 v[48:51], v4 offset:49152
    s_waitcnt lgkmcnt(3)
    v_mfma_f32_32x32x16_bf16 v[32:47], v[200:203], v[52:55], v[32:47]
    ds_read_b128 v[52:55], v4 offset:50176
    s_waitcnt lgkmcnt(3)
    v_mfma_f32_32x32x16_bf16 v[16:31], v[204:207], v[56:59], v[16:31]
    ds_read_b128 v[56:59], v4 offset:51200
    s_waitcnt lgkmcnt(3)
    v_mfma_f32_32x32x16_bf16 v[32:47], v[204:207], v[60:63], v[32:47]
    ds_read_b128 v[60:63], v4 offset:52224
    s_waitcnt lgkmcnt(3)
    v_mfma_f32_32x32x16_bf16 v[16:31], v[208:211], v[48:51], v[16:31]
    ds_read_b128 v[48:51], v4 offset:53248
    s_waitcnt lgkmcnt(3)
    v_mfma_f32_32x32x16_bf16 v[16:31], v[212:215], v[52:55], v[16:31]
    ds_read_b128 v[52:55], v4 offset:54272
    s_waitcnt lgkmcnt(3)
    v_mfma_f32_32x32x16_bf16 v[16:31], v[216:219], v[56:59], v[16:31]
    ds_read_b128 v[56:59], v4 offset:55296
    s_waitcnt lgkmcnt(3)
    v_mfma_f32_32x32x16_bf16 v[16:31], v[220:223], v[60:63], v[16:31]
    ds_read_b128 v[60:63], v4 offset:56320
    s_waitcnt lgkmcnt(3)
    v_mfma_f32_32x32x16_bf16 v[32:47], v[208:211], v[48:51], v[32:47]
    s_waitcnt lgkmcnt(2)
    v_mfma_f32_32x32x16_bf16 v[32:47], v[212:215], v[52:55], v[32:47]
    s_waitcnt lgkmcnt(1)
    v_mfma_f32_32x32x16_bf16 v[32:47], v[216:219], v[56:59], v[32:47]
    s_waitcnt lgkmcnt(0)
    v_mfma_f32_32x32x16_bf16 v[32:47], v[220:223], v[60:63], v[32:47]
    s_nop 3
    ds_write_b128 v240, v[16:19] offset:0
    ds_write_b128 v241, v[20:23] offset:0
    ds_write_b128 v242, v[24:27] offset:0
    ds_write_b128 v243, v[28:31] offset:0
    s_nop 3
    ds_write_b128 v240, v[32:35] offset:8192
    ds_write_b128 v241, v[36:39] offset:8192
    ds_write_b128 v242, v[40:43] offset:8192
    ds_write_b128 v243, v[44:47] offset:8192
    s_waitcnt lgkmcnt(0)
    s_barrier
    ds_read_b128 v[16:19], v244
    ds_read_b128 v[24:27], v244 offset:16384
    ds_read_b128 v[20:23], v245
    ds_read_b128 v[28:31], v245 offset:16384
    s_waitcnt lgkmcnt(2)
    v_pk_add_f32 v[224:225], v[224:225], v[16:17]
    v_pk_add_f32 v[224:225], v[224:225], v[24:25]
    v_pk_add_f32 v[226:227], v[226:227], v[18:19]
    v_pk_add_f32 v[226:227], v[226:227], v[26:27]
    v_cvt_pk_bf16_f32 v252, v224, v225
    v_cvt_pk_bf16_f32 v253, v226, v227
    s_waitcnt lgkmcnt(0)
    v_pk_add_f32 v[228:229], v[228:229], v[20:21]
    v_pk_add_f32 v[228:229], v[228:229], v[28:29]
    v_pk_add_f32 v[230:231], v[230:231], v[22:23]
    v_pk_add_f32 v[230:231], v[230:231], v[30:31]
    v_cvt_pk_bf16_f32 v254, v228, v229
    v_cvt_pk_bf16_f32 v255, v230, v231
L_p3_done:
    buffer_store_dwordx4 v[252:255], v2, s[28:31], s74 offen sc1
    v_dot2_f32_bf16 v16, v252, v10, 0
    v_dot2_f32_bf16 v17, v252, v252, 0
    v_dot2_f32_bf16 v16, v253, v10, v16
    v_dot2_f32_bf16 v17, v253, v253, v17
    v_dot2_f32_bf16 v16, v254, v10, v16
    v_dot2_f32_bf16 v17, v254, v254, v17
    v_dot2_f32_bf16 v16, v255, v10, v16
    v_dot2_f32_bf16 v17, v255, v255, v17
    s_nop 1
    s_nop 0
    v_add_f32_dpp v16, v16, v16 quad_perm:[1,0,3,2] row_mask:0xf bank_mask:0xf
    v_add_f32_dpp v17, v17, v17 quad_perm:[1,0,3,2] row_mask:0xf bank_mask:0xf
    s_nop 0
    v_add_f32_dpp v16, v16, v16 quad_perm:[2,3,0,1] row_mask:0xf bank_mask:0xf
    v_add_f32_dpp v17, v17, v17 quad_perm:[2,3,0,1] row_mask:0xf bank_mask:0xf
    s_nop 0
    v_add_f32_dpp v16, v16, v16 row_half_mirror row_mask:0xf bank_mask:0xf
    v_add_f32_dpp v17, v17, v17 row_half_mirror row_mask:0xf bank_mask:0xf
    s_mov_b32 exec_lo, 0x01010101
    s_mov_b32 exec_hi, 0x01010101
    buffer_store_dwordx2 v[16:17], v7, s[28:31], s78 offen sc1
    s_mov_b64 exec, -1
    v_mov_b32 v41, v7
    s_cmp_lt_u32 s3, 4
    s_cbranch_scc1 L_p4_a
    v_lshrrev_b32 v10, 4, v0
    v_xor_b32 v10, v10, v0
    v_and_b32 v10, 7, v10
    v_and_b32 v3, 0x7c00, v2
    v_lshl_add_u32 v3, v10, 4, v3
    s_and_b32 s75, s3, 3
    s_lshl_b32 s75, s75, 13
    s_add_u32 s76, s75, 6422528
    s_add_u32 s76, s76, s60
    s_waitcnt vmcnt(0)
    s_mov_b32 exec_lo, 0x01010101
    s_mov_b32 exec_hi, 0x01010101
    buffer_load_dword v251, v2, s[28:31], s74 offen sc1
    s_mov_b64 exec, 1
    buffer_load_dword v251, v41, s[28:31], s78 offen sc1
    s_mov_b64 exec, -1
    s_barrier
    s_cmp_lg_u32 s3, 4
    s_cbranch_scc1 L_nf_21
    s_mov_b64 exec, 1
    buffer_store_dword v248, v249, s[28:31], s98 offen offset:128 sc1
    s_mov_b64 exec, -1
L_nf_21:
    s_add_u32 m0, s97, 65536
    s_add_u32 s79, s88, 128
    buffer_load_dwordx4 v13, s[20:23], s79 offen  lds
    s_add_u32 m0, s97, 66560
    s_add_u32 s79, s88, 22144
    buffer_load_dwordx4 v13, s[20:23], s79 offen  lds
    s_add_u32 m0, s97, 67584
    s_add_u32 s79, s88, 44160
    buffer_load_dwordx4 v13, s[20:23], s79 offen  lds
    s_add_u32 m0, s97, 68608
    s_add_u32 s79, s88, 66176
    buffer_load_dwordx4 v13, s[20:23], s79 offen  lds
    s_add_u32 m0, s97, 81920
    s_add_u32 s79, s89, 128
    buffer_load_dwordx4 v13, s[20:23], s79 offen  lds
    s_add_u32 m0, s97, 82944
    s_add_u32 s79, s89, 22144
    buffer_load_dwordx4 v13, s[20:23], s79 offen  lds
    s_add_u32 m0, s97, 83968
    s_add_u32 s79, s89, 44160
    buffer_load_dwordx4 v13, s[20:23], s79 offen  lds
    s_add_u32 m0, s97, 84992
    s_add_u32 s79, s89, 66176
    buffer_load_dwordx4 v13, s[20:23], s79 offen  lds
    s_cmp_lg_u32 s3, 4
    s_cbranch_scc1 L_w_22
    s_add_u32 s46, s99, 128
    s_load_dwordx8 s[48:55], s[64:65], s46 glc
    s_mov_b32 s44, s70
    s_mov_b32 s45, s70
    s_mov_b32 s47, 0
L_w_22:
    s_cmp_lg_u32 s3, 4
    s_cbranch_scc1 L_h_seen
L_sp_23:
    s_waitcnt lgkmcnt(0)
    s_xor_b64 s[48:49], s[48:49], s[44:45]
    s_xor_b64 s[50:51], s[50:51], s[44:45]
    s_xor_b64 s[52:53], s[52:53], s[44:45]
    s_xor_b64 s[54:55], s[54:55], s[44:45]
    s_or_b64 s[48:49], s[48:49], s[50:51]
    s_or_b64 s[48:49], s[48:49], s[52:53]
    s_or_b64 s[48:49], s[48:49], s[54:55]
    s_cbranch_scc0 L_spok_24
    s_load_dwordx8 s[48:55], s[64:65], s46 glc
    s_add_u32 s47, s47, 1
    s_cmp_lt_u32 s47, 16
    s_cbranch_scc1 L_sp_23
    s_waitcnt lgkmcnt(0)
    v_not_b32 v247, v248
    v_cmp_eq_u32 vcc, v247, v248
    s_nop 0
    s_and_b32 s79, vcc_lo, 0xff
    s_cmp_eq_u32 s79, 0xff
    s_cbranch_scc1 L_skip_25
    s_mov_b32 exec_hi, 0
    s_mov_b32 exec_lo, 0xff
    s_mov_b32 s93, 0
L_poll_26:
    buffer_load_dword v247, v249, s[28:31], s99 offen offset:128 sc1
    s_add_u32 s93, s93, 1
    s_waitcnt vmcnt(0)
    v_cmp_eq_u32 vcc, v247, v248
    s_cmp_gt_u32 s93, 200000
    s_cbranch_scc1 L_done_27
    s_cmp_eq_u64 vcc, exec
    s_cbranch_scc0 L_poll_26
L_done_27:
    s_mov_b64 exec, -1
L_skip_25:
L_spok_24:
L_h_seen:
    s_barrier
    s_add_u32 m0, s75, 0
    s_add_u32 s79, s76, 0
    buffer_load_dwordx4 v3, s[28:31], s79 offen sc1 lds
    s_add_u32 m0, s75, 32768
    s_add_u32 s79, s76, 65536
    buffer_load_dwordx4 v3, s[28:31], s79 offen sc1 lds
    s_add_u32 m0, s75, 1024
    s_add_u32 s79, s76, 128
    buffer_load_dwordx4 v3, s[28:31], s79 offen sc1 lds
    s_add_u32 m0, s75, 33792
    s_add_u32 s79, s76, 65664
    buffer_load_dwordx4 v3, s[28:31], s79 offen sc1 lds
    s_add_u32 m0, s75, 2048
    s_add_u32 s79, s76, 256
    buffer_load_dwordx4 v3, s[28:31], s79 offen sc1 lds
    s_add_u32 m0, s75, 34816
    s_add_u32 s79, s76, 65792
    buffer_load_dwordx4 v3, s[28:31], s79 offen sc1 lds
    s_add_u32 m0, s75, 3072
    s_add_u32 s79, s76, 384
    buffer_load_dwordx4 v3, s[28:31], s79 offen sc1 lds
    s_add_u32 m0, s75, 35840
    s_add_u32 s79, s76, 65920
    buffer_load_dwordx4 v3, s[28:31], s79 offen sc1 lds
    s_add_u32 m0, s75, 4096
    s_add_u32 s79, s76, 512
    buffer_load_dwordx4 v3, s[28:31], s79 offen sc1 lds
    s_add_u32 m0, s75, 36864
    s_add_u32 s79, s76, 66048
    buffer_load_dwordx4 v3, s[28:31], s79 offen sc1 lds
    s_add_u32 m0, s75, 5120
    s_add_u32 s79, s76, 640
    buffer_load_dwordx4 v3, s[28:31], s79 offen sc1 lds
    s_add_u32 m0, s75, 37888
    s_add_u32 s79, s76, 66176
    buffer_load_dwordx4 v3, s[28:31], s79 offen sc1 lds
    s_waitcnt vmcnt(8)
    s_barrier
    s_add_u32 m0, s75, 6144
    s_add_u32 s79, s76, 768
    buffer_load_dwordx4 v3, s[28:31], s79 offen sc1 lds
    s_add_u32 m0, s75, 38912
    s_add_u32 s79, s76, 66304
    buffer_load_dwordx4 v3, s[28:31], s79 offen sc1 lds
    s_add_u32 m0, s75, 7168
    s_add_u32 s79, s76, 896
    buffer_load_dwordx4 v3, s[28:31], s79 offen sc1 lds
    s_add_u32 m0, s75, 39936
    s_add_u32 s79, s76, 66432
    buffer_load_dwordx4 v3, s[28:31], s79 offen sc1 lds
    s_waitcnt vmcnt(8)
    s_barrier
    s_waitcnt vmcnt(4)
    s_barrier
    s_add_u32 m0, s97, 98304
    s_add_u32 s79, s86, 256
    buffer_load_dwordx4 v13, s[20:23], s79 offen  lds
    s_add_u32 m0, s97, 99328
    s_add_u32 s79, s86, 22272
    buffer_load_dwordx4 v13, s[20:23], s79 offen  lds
    s_add_u32 m0, s97, 100352
    s_add_u32 s79, s86, 44288
    buffer_load_dwordx4 v13, s[20:23], s79 offen  lds
    s_add_u32 m0, s97, 101376
    s_add_u32 s79, s86, 66304
    buffer_load_dwordx4 v13, s[20:23], s79 offen  lds
    s_waitcnt vmcnt(4)
    s_barrier
    s_add_u32 m0, s97, 114688
    s_add_u32 s79, s87, 256
    buffer_load_dwordx4 v13, s[20:23], s79 offen  lds
    s_add_u32 m0, s97, 115712
    s_add_u32 s79, s87, 22272
    buffer_load_dwordx4 v13, s[20:23], s79 offen  lds
    s_add_u32 m0, s97, 116736
    s_add_u32 s79, s87, 44288
    buffer_load_dwordx4 v13, s[20:23], s79 offen  lds
    s_add_u32 m0, s97, 117760
    s_add_u32 s79, s87, 66304
    buffer_load_dwordx4 v13, s[20:23], s79 offen  lds
    s_and_b32 s72, s3, 3
    s_lshl_b32 s75, s72, 10
    s_lshl_b32 s72, s72, 11
    s_add_u32 s72, s72, s60
    s_add_u32 s76, s72, 6553600
    s_and_b32 s72, s3, 2
    s_lshl_b32 s72, s72, 12
    v_add_u32 v4, s72, v246
    v_add_u32 v5, 65536, v4
    v_add_u32 v6, 131072, v4
    s_barrier
    s_add_u32 m0, s97, 131072
    s_add_u32 s79, s88, 256
    buffer_load_dwordx4 v13, s[20:23], s79 offen  lds
    s_add_u32 m0, s97, 132096
    s_add_u32 s79, s88, 22272
    buffer_load_dwordx4 v13, s[20:23], s79 offen  lds
    s_add_u32 m0, s97, 133120
    s_add_u32 s79, s88, 44288
    buffer_load_dwordx4 v13, s[20:23], s79 offen  lds
    s_add_u32 m0, s97, 134144
    s_add_u32 s79, s88, 66304
    buffer_load_dwordx4 v13, s[20:23], s79 offen  lds
    s_waitcnt vmcnt(4)
    s_barrier
    s_add_u32 m0, s97, 147456
    s_add_u32 s79, s89, 256
    buffer_load_dwordx4 v13, s[20:23], s79 offen  lds
    s_add_u32 m0, s97, 148480
    s_add_u32 s79, s89, 22272
    buffer_load_dwordx4 v13, s[20:23], s79 offen  lds
    s_add_u32 m0, s97, 149504
    s_add_u32 s79, s89, 44288
    buffer_load_dwordx4 v13, s[20:23], s79 offen  lds
    s_add_u32 m0, s97, 150528
    s_add_u32 s79, s89, 66304
    buffer_load_dwordx4 v13, s[20:23], s79 offen  lds
    s_barrier
    s_cmp_lg_u32 s3, 4
    s_cbranch_scc1 L_nf_28
    s_mov_b64 exec, 1
    buffer_store_dword v248, v249, s[28:31], s98 offen offset:256 sc1
    s_mov_b64 exec, -1
L_nf_28:
    s_waitcnt vmcnt(0)
    s_cmp_lg_u32 s3, 4
    s_cbranch_scc1 L_w_29
    s_add_u32 s46, s99, 256
    s_load_dwordx8 s[48:55], s[64:65], s46 glc
    s_mov_b32 s44, s70
    s_mov_b32 s45, s70
    s_mov_b32 s47, 0
L_w_29:
    s_barrier
    s_cmp_lg_u32 s3, 4
    s_cbranch_scc1 L_w_30
L_sp_31:
    s_waitcnt lgkmcnt(0)
    s_xor_b64 s[48:49], s[48:49], s[44:45]
    s_xor_b64 s[50:51], s[50:51], s[44:45]
    s_xor_b64 s[52:53], s[52:53], s[44:45]
    s_xor_b64 s[54:55], s[54:55], s[44:45]
    s_or_b64 s[48:49], s[48:49], s[50:51]
    s_or_b64 s[48:49], s[48:49], s[52:53]
    s_or_b64 s[48:49], s[48:49], s[54:55]
    s_cbranch_scc0 L_spok_32
    s_load_dwordx8 s[48:55], s[64:65], s46 glc
    s_add_u32 s47, s47, 1
    s_cmp_lt_u32 s47, 16
    s_cbranch_scc1 L_sp_31
    s_waitcnt lgkmcnt(0)
    v_not_b32 v247, v248
    v_cmp_eq_u32 vcc, v247, v248
    s_nop 0
    s_and_b32 s79, vcc_lo, 0xff
    s_cmp_eq_u32 s79, 0xff
    s_cbranch_scc1 L_skip_33
    s_mov_b32 exec_hi, 0
    s_mov_b32 exec_lo, 0xff
    s_mov_b32 s93, 0
L_poll_34:
    buffer_load_dword v247, v249, s[28:31], s99 offen offset:256 sc1
    s_add_u32 s93, s93, 1
    s_waitcnt vmcnt(0)
    v_cmp_eq_u32 vcc, v247, v248
    s_cmp_gt_u32 s93, 200000
    s_cbranch_scc1 L_done_35
    s_cmp_eq_u64 vcc, exec
    s_cbranch_scc0 L_poll_34
L_done_35:
    s_mov_b64 exec, -1
L_skip_33:
L_spok_32:
L_w_30:
    s_barrier
    s_cmp_lg_u32 s3, 4
    s_cbranch_scc1 L_nf_36
    s_mov_b64 exec, 1
    buffer_store_dword v248, v249, s[28:31], s98 offen offset:384 sc1
    s_mov_b64 exec, -1
L_nf_36:
    s_add_u32 m0, s75, 0
    s_add_u32 s79, s76, 0
    buffer_load_dwordx4 v246, s[28:31], s79 offen sc1 lds
    s_add_u32 m0, s75, 4096
    s_add_u32 s79, s76, 180224
    buffer_load_dwordx4 v246, s[28:31], s79 offen sc1 lds
    s_add_u32 m0, s75, 8192
    s_add_u32 s79, s76, 1024
    buffer_load_dwordx4 v246, s[28:31], s79 offen sc1 lds
    s_add_u32 m0, s75, 12288
    s_add_u32 s79, s76, 181248
    buffer_load_dwordx4 v246, s[28:31], s79 offen sc1 lds
    s_add_u32 m0, s75, 16384
    s_add_u32 s79, s76, 16384
    buffer_load_dwordx4 v246, s[28:31], s79 offen sc1 lds
    s_add_u32 m0, s75, 20480
    s_add_u32 s79, s76, 196608
    buffer_load_dwordx4 v246, s[28:31], s79 offen sc1 lds
    s_add_u32 m0, s75, 24576
    s_add_u32 s79, s76, 17408
    buffer_load_dwordx4 v246, s[28:31], s79 offen sc1 lds
    s_add_u32 m0, s75, 28672
    s_add_u32 s79, s76, 197632
    buffer_load_dwordx4 v246, s[28:31], s79 offen sc1 lds
    s_waitcnt vmcnt(4)
    s_add_u32 m0, s75, 32768
    s_add_u32 s79, s76, 32768
    buffer_load_dwordx4 v246, s[28:31], s79 offen sc1 lds
    s_add_u32 m0, s75, 36864
    s_add_u32 s79, s76, 212992
    buffer_load_dwordx4 v246, s[28:31], s79 offen sc1 lds
    s_add_u32 m0, s75, 40960
    s_add_u32 s79, s76, 33792
    buffer_load_dwordx4 v246, s[28:31], s79 offen sc1 lds
    s_add_u32 m0, s75, 45056
    s_add_u32 s79, s76, 214016
    buffer_load_dwordx4 v246, s[28:31], s79 offen sc1 lds
    s_waitcnt vmcnt(4)
    s_barrier
    ds_read_b128 v[48:51], v4 offset:0
    ds_read_b128 v[52:55], v4 offset:4096
    ds_read_b128 v[56:59], v4 offset:1024
    ds_read_b128 v[60:63], v4 offset:5120
    s_waitcnt lgkmcnt(3)
    v_mfma_f32_32x32x16_bf16 v[16:31], v[140:143], v[48:51], 0
    ds_read_b128 v[48:51], v4 offset:2048
    s_waitcnt lgkmcnt(3)
    v_mfma_f32_32x32x16_bf16 v[32:47], v[140:143], v[52:55], 0
    ds_read_b128 v[52:55], v4 offset:6144
    s_waitcnt lgkmcnt(3)
    v_mfma_f32_32x32x16_bf16 v[16:31], v[144:147], v[56:59], v[16:31]
    ds_read_b128 v[56:59], v4 offset:3072
    s_waitcnt lgkmcnt(3)
    v_mfma_f32_32x32x16_bf16 v[32:47], v[144:147], v[60:63], v[32:47]
    ds_read_b128 v[60:63], v4 offset:7168
    s_waitcnt lgkmcnt(3)
    v_mfma_f32_32x32x16_bf16 v[16:31], v[148:151], v[48:51], v[16:31]
    ds_read_b128 v[48:51], v4 offset:16384
    s_waitcnt lgkmcnt(3)
    v_mfma_f32_32x32x16_bf16 v[32:47], v[148:151], v[52:55], v[32:47]
    ds_read_b128 v[52:55], v4 offset:20480
    s_waitcnt lgkmcnt(3)
    v_mfma_f32_32x32x16_bf16 v[16:31], v[152:155], v[56:59], v[16:31]
    ds_read_b128 v[56:59], v4 offset:17408
    s_waitcnt lgkmcnt(3)
    v_mfma_f32_32x32x16_bf16 v[32:47], v[152:155], v[60:63], v[32:47]
    ds_read_b128 v[60:63], v4 offset:21504
    s_waitcnt lgkmcnt(3)
    v_mfma_f32_32x32x16_bf16 v[16:31], v[156:159], v[48:51], v[16:31]
    ds_read_b128 v[48:51], v4 offset:18432
    s_waitcnt lgkmcnt(3)
    v_mfma_f32_32x32x16_bf16 v[32:47], v[156:159], v[52:55], v[32:47]
    ds_read_b128 v[52:55], v4 offset:22528
    s_waitcnt lgkmcnt(3)
    v_mfma_f32_32x32x16_bf16 v[16:31], v[160:163], v[56:59], v[16:31]
    ds_read_b128 v[56:59], v4 offset:19456
    s_waitcnt lgkmcnt(3)
    v_mfma_f32_32x32x16_bf16 v[32:47], v[160:163], v[60:63], v[32:47]
    ds_read_b128 v[60:63], v4 offset:23552
    s_waitcnt lgkmcnt(3)
    v_mfma_f32_32x32x16_bf16 v[16:31], v[164:167], v[48:51], v[16:31]
    s_waitcnt vmcnt(0)
    s_barrier
    ds_read_b128 v[48:51], v4 offset:32768
    v_lshlrev_b32 v140, 16, v252
    s_waitcnt lgkmcnt(3)
    v_mfma_f32_32x32x16_bf16 v[32:47], v[164:167], v[52:55], v[32:47]
    ds_read_b128 v[52:55], v4 offset:36864
    v_and_b32 v141, 0xffff0000, v252
    s_waitcnt lgkmcnt(3)
    v_mfma_f32_32x32x16_bf16 v[16:31], v[168:171], v[56:59], v[16:31]
    ds_read_b128 v[56:59], v4 offset:33792
    v_lshlrev_b32 v142, 16, v253
    s_waitcnt lgkmcnt(3)
    v_mfma_f32_32x32x16_bf16 v[32:47], v[168:171], v[60:63], v[32:47]
    ds_read_b128 v[60:63], v4 offset:37888
    v_and_b32 v143, 0xffff0000, v253
    s_waitcnt lgkmcnt(3)
    v_mfma_f32_32x32x16_bf16 v[16:31], v[172:175], v[48:51], v[16:31]
    ds_read_b128 v[48:51], v4 offset:34816
    v_lshlrev_b32 v144, 16, v254
    s_waitcnt lgkmcnt(3)
    v_mfma_f32_32x32x16_bf16 v[32:47], v[172:175], v[52:55], v[32:47]
    ds_read_b128 v[52:55], v4 offset:38912
    v_and_b32 v145, 0xffff0000, v254
    s_waitcnt lgkmcnt(3)
    v_mfma_f32_32x32x16_bf16 v[16:31], v[176:179], v[56:59], v[16:31]
    ds_read_b128 v[56:59], v4 offset:35840
    v_lshlrev_b32 v146, 16, v255
    s_waitcnt lgkmcnt(3)
    v_mfma_f32_32x32x16_bf16 v[32:47], v[176:179], v[60:63], v[32:47]
    ds_read_b128 v[60:63], v4 offset:39936
    v_and_b32 v147, 0xffff0000, v255
    s_waitcnt lgkmcnt(3)
    v_mfma_f32_32x32x16_bf16 v[16:31], v[180:183], v[48:51], v[16:31]
    s_barrier
    ds_read_b128 v[48:51], v4 offset:49152
    v_lshlrev_b32 v148, 16, v236
    s_waitcnt lgkmcnt(3)
    v_mfma_f32_32x32x16_bf16 v[32:47], v[180:183], v[52:55], v[32:47]
    ds_read_b128 v[52:55], v4 offset:53248
    v_and_b32 v149, 0xffff0000, v236
    s_waitcnt lgkmcnt(3)
    v_mfma_f32_32x32x16_bf16 v[16:31], v[184:187], v[56:59], v[16:31]
    ds_read_b128 v[56:59], v4 offset:50176
    v_lshlrev_b32 v150, 16, v237
    s_waitcnt lgkmcnt(3)
    v_mfma_f32_32x32x16_bf16 v[32:47], v[184:187], v[60:63], v[32:47]
    ds_read_b128 v[60:63], v4 offset:54272
    v_and_b32 v151, 0xffff0000, v237
    s_waitcnt lgkmcnt(3)
    v_mfma_f32_32x32x16_bf16 v[16:31], v[188:191], v[48:51], v[16:31]
    ds_read_b128 v[48:51], v4 offset:51200
    v_lshlrev_b32 v152, 16, v238
    s_waitcnt lgkmcnt(3)
    v_mfma_f32_32x32x16_bf16 v[32:47], v[188:191], v[52:55], v[32:47]
    ds_read_b128 v[52:55], v4 offset:55296
    s_waitcnt lgkmcnt(3)
    v_mfma_f32_32x32x16_bf16 v[16:31], v[192:195], v[56:59], v[16:31]
    ds_read_b128 v[56:59], v4 offset:52224
    v_and_b32 v153, 0xffff0000, v238
    s_waitcnt lgkmcnt(3)
    v_mfma_f32_32x32x16_bf16 v[32:47], v[192:195], v[60:63], v[32:47]
    ds_read_b128 v[60:63], v4 offset:56320
    v_lshlrev_b32 v154, 16, v239
    s_waitcnt lgkmcnt(3)
    v_mfma_f32_32x32x16_bf16 v[16:31], v[196:199], v[48:51], v[16:31]
    s_barrier
    ds_read_b128 v[48:51], v5 offset:0
    v_and_b32 v155, 0xffff0000, v239
    s_waitcnt lgkmcnt(3)
    v_mfma_f32_32x32x16_bf16 v[32:47], v[196:199], v[52:55], v[32:47]
    ds_read_b128 v[52:55], v5 offset:4096
    v_add_f32 v140, v140, v148
    s_waitcnt lgkmcnt(3)
    v_mfma_f32_32x32x16_bf16 v[16:31], v[200:203], v[56:59], v[16:31]
    ds_read_b128 v[56:59], v5 offset:1024
    v_add_f32 v141, v141, v149
    s_waitcnt lgkmcnt(3)
    v_mfma_f32_32x32x16_bf16 v[32:47], v[200:203], v[60:63], v[32:47]
    ds_read_b128 v[60:63], v5 offset:5120
    v_add_f32 v142, v142, v150
    s_waitcnt lgkmcnt(3)
    v_mfma_f32_32x32x16_bf16 v[16:31], v[204:207], v[48:51], v[16:31]
    ds_read_b128 v[48:51], v5 offset:2048
    v_add_f32 v143, v143, v151
    s_waitcnt lgkmcnt(3)
    v_mfma_f32_32x32x16_bf16 v[32:47], v[204:207], v[52:55], v[32:47]
    ds_read_b128 v[52:55], v5 offset:6144
    v_add_f32 v144, v144, v152
    s_waitcnt lgkmcnt(3)
    v_mfma_f32_32x32x16_bf16 v[16:31], v[208:211], v[56:59], v[16:31]
    ds_read_b128 v[56:59], v5 offset:3072
    v_add_f32 v145, v145, v153
    s_waitcnt lgkmcnt(3)
    v_mfma_f32_32x32x16_bf16 v[32:47], v[208:211], v[60:63], v[32:47]
    ds_read_b128 v[60:63], v5 offset:7168
    v_add_f32 v146, v146, v154
    s_waitcnt lgkmcnt(3)
    v_mfma_f32_32x32x16_bf16 v[16:31], v[212:215], v[48:51], v[16:31]
    s_barrier
    ds_read_b128 v[48:51], v5 offset:16384
    v_add_f32 v147, v147, v155
    s_waitcnt lgkmcnt(3)
    v_mfma_f32_32x32x16_bf16 v[32:47], v[212:215], v[52:55], v[32:47]
    ds_read_b128 v[52:55], v5 offset:20480
    v_mov_b32 v10, 0xc0088e99
    s_waitcnt lgkmcnt(3)
    v_mfma_f32_32x32x16_bf16 v[16:31], v[216:219], v[56:59], v[16:31]
    ds_read_b128 v[56:59], v5 offset:17408
    v_mov_b32 v11, v10
    s_waitcnt lgkmcnt(3)
    v_mfma_f32_32x32x16_bf16 v[32:47], v[216:219], v[60:63], v[32:47]
    ds_read_b128 v[60:63], v5 offset:21504
    s_waitcnt lgkmcnt(3)
    v_mfma_f32_32x32x16_bf16 v[16:31], v[220:223], v[48:51], v[16:31]
    ds_read_b128 v[48:51], v5 offset:18432
    s_waitcnt lgkmcnt(3)
    v_mfma_f32_32x32x16_bf16 v[32:47], v[220:223], v[52:55], v[32:47]
    ds_read_b128 v[52:55], v5 offset:22528
    s_waitcnt lgkmcnt(3)
    v_mfma_f32_32x32x16_bf16 v[16:31], v[224:227], v[56:59], v[16:31]
    ds_read_b128 v[56:59], v5 offset:19456
    s_waitcnt lgkmcnt(3)
    v_mfma_f32_32x32x16_bf16 v[32:47], v[224:227], v[60:63], v[32:47]
    ds_read_b128 v[60:63], v5 offset:23552
    s_waitcnt lgkmcnt(3)
    v_mfma_f32_32x32x16_bf16 v[16:31], v[228:231], v[48:51], v[16:31]
    s_barrier
    ds_read_b128 v[48:51], v5 offset:32768
    s_waitcnt lgkmcnt(3)
    v_mfma_f32_32x32x16_bf16 v[32:47], v[228:231], v[52:55], v[32:47]
    ds_read_b128 v[52:55], v5 offset:36864
    s_waitcnt lgkmcnt(3)
    v_mfma_f32_32x32x16_bf16 v[16:31], v[232:235], v[56:59], v[16:31]
    ds_read_b128 v[56:59], v5 offset:33792
    s_waitcnt lgkmcnt(3)
    v_mfma_f32_32x32x16_bf16 v[32:47], v[232:235], v[60:63], v[32:47]
    ds_read_b128 v[60:63], v5 offset:37888
    s_waitcnt lgkmcnt(3)
    v_mfma_f32_32x32x16_bf16 v[16:31], v[64:67], v[48:51], v[16:31]
    ds_read_b128 v[48:51], v5 offset:34816
    s_waitcnt lgkmcnt(3)
    v_mfma_f32_32x32x16_bf16 v[32:47], v[64:67], v[52:55], v[32:47]
    ds_read_b128 v[52:55], v5 offset:38912
    s_waitcnt lgkmcnt(3)
    v_mfma_f32_32x32x16_bf16 v[16:31], v[68:71], v[56:59], v[16:31]
    ds_read_b128 v[56:59], v5 offset:35840
    s_waitcnt lgkmcnt(3)
    v_mfma_f32_32x32x16_bf16 v[32:47], v[68:71], v[60:63], v[32:47]
    ds_read_b128 v[60:63], v5 offset:39936
    s_waitcnt lgkmcnt(3)
    v_mfma_f32_32x32x16_bf16 v[16:31], v[72:75], v[48:51], v[16:31]
    s_barrier
    ds_read_b128 v[48:51], v5 offset:49152
    s_waitcnt lgkmcnt(3)
    v_mfma_f32_32x32x16_bf16 v[32:47], v[72:75], v[52:55], v[32:47]
    ds_read_b128 v[52:55], v5 offset:53248
    s_waitcnt lgkmcnt(3)
    v_mfma_f32_32x32x16_bf16 v[16:31], v[76:79], v[56:59], v[16:31]
    ds_read_b128 v[56:59], v5 offset:50176
    s_waitcnt lgkmcnt(3)
    v_mfma_f32_32x32x16_bf16 v[32:47], v[76:79], v[60:63], v[32:47]
    ds_read_b128 v[60:63], v5 offset:54272
    s_waitcnt lgkmcnt(3)
    v_mfma_f32_32x32x16_bf16 v[16:31], v[80:83], v[48:51], v[16:31]
    ds_read_b128 v[48:51], v5 offset:51200
    s_waitcnt lgkmcnt(3)
    v_mfma_f32_32x32x16_bf16 v[32:47], v[80:83], v[52:55], v[32:47]
    ds_read_b128 v[52:55], v5 offset:55296
    s_waitcnt lgkmcnt(3)
    v_mfma_f32_32x32x16_bf16 v[16:31], v[84:87], v[56:59], v[16:31]
    ds_read_b128 v[56:59], v5 offset:52224
    s_waitcnt lgkmcnt(3)
    v_mfma_f32_32x32x16_bf16 v[32:47], v[84:87], v[60:63], v[32:47]
    ds_read_b128 v[60:63], v5 offset:56320
    s_waitcnt lgkmcnt(3)
    v_mfma_f32_32x32x16_bf16 v[16:31], v[88:91], v[48:51], v[16:31]
    s_barrier
    ds_read_b128 v[48:51], v6 offset:0
    s_waitcnt lgkmcnt(3)
    v_mfma_f32_32x32x16_bf16 v[32:47], v[88:91], v[52:55], v[32:47]
    ds_read_b128 v[52:55], v6 offset:4096
    s_waitcnt lgkmcnt(3)
    v_mfma_f32_32x32x16_bf16 v[16:31], v[92:95], v[56:59], v[16:31]
    ds_read_b128 v[56:59], v6 offset:1024
    s_waitcnt lgkmcnt(3)
    v_mfma_f32_32x32x16_bf16 v[32:47], v[92:95], v[60:63], v[32:47]
    ds_read_b128 v[60:63], v6 offset:5120
    s_waitcnt lgkmcnt(3)
    v_mfma_f32_32x32x16_bf16 v[16:31], v[96:99], v[48:51], v[16:31]
    ds_read_b128 v[48:51], v6 offset:2048
    s_waitcnt lgkmcnt(3)
    v_mfma_f32_32x32x16_bf16 v[32:47], v[96:99], v[52:55], v[32:47]
    ds_read_b128 v[52:55], v6 offset:6144
    s_waitcnt lgkmcnt(3)
    v_mfma_f32_32x32x16_bf16 v[16:31], v[100:103], v[56:59], v[16:31]
    ds_read_b128 v[56:59], v6 offset:3072
    s_waitcnt lgkmcnt(3)
    v_mfma_f32_32x32x16_bf16 v[32:47], v[100:103], v[60:63], v[32:47]
    ds_read_b128 v[60:63], v6 offset:7168
    s_waitcnt lgkmcnt(3)
    v_mfma_f32_32x32x16_bf16 v[16:31], v[104:107], v[48:51], v[16:31]
    s_barrier
    ds_read_b128 v[48:51], v6 offset:16384
    s_waitcnt lgkmcnt(3)
    v_mfma_f32_32x32x16_bf16 v[32:47], v[104:107], v[52:55], v[32:47]
    ds_read_b128 v[52:55], v6 offset:20480
    s_waitcnt lgkmcnt(3)
    v_mfma_f32_32x32x16_bf16 v[16:31], v[108:111], v[56:59], v[16:31]
    ds_read_b128 v[56:59], v6 offset:17408
    s_waitcnt lgkmcnt(3)
    v_mfma_f32_32x32x16_bf16 v[32:47], v[108:111], v[60:63], v[32:47]
    ds_read_b128 v[60:63], v6 offset:21504
    s_waitcnt lgkmcnt(3)
    v_mfma_f32_32x32x16_bf16 v[16:31], v[112:115], v[48:51], v[16:31]
    ds_read_b128 v[48:51], v6 offset:18432
    s_waitcnt lgkmcnt(3)
    v_mfma_f32_32x32x16_bf16 v[32:47], v[112:115], v[52:55], v[32:47]
    ds_read_b128 v[52:55], v6 offset:22528
    s_waitcnt lgkmcnt(3)
    v_mfma_f32_32x32x16_bf16 v[16:31], v[116:119], v[56:59], v[16:31]
    ds_read_b128 v[56:59], v6 offset:19456
    s_waitcnt lgkmcnt(3)
    v_mfma_f32_32x32x16_bf16 v[32:47], v[116:119], v[60:63], v[32:47]
    ds_read_b128 v[60:63], v6 offset:23552
    s_waitcnt lgkmcnt(3)
    v_mfma_f32_32x32x16_bf16 v[16:31], v[120:123], v[48:51], v[16:31]
    s_barrier
    ds_read_b128 v[48:51], v4 offset:32768
    s_waitcnt lgkmcnt(3)
    v_mfma_f32_32x32x16_bf16 v[32:47], v[120:123], v[52:55], v[32:47]
    ds_read_b128 v[52:55], v4 offset:33792
    s_waitcnt lgkmcnt(3)
    v_mfma_f32_32x32x16_bf16 v[16:31], v[124:127], v[56:59], v[16:31]
    ds_read_b128 v[56:59], v4 offset:34816
    s_waitcnt lgkmcnt(3)
    v_mfma_f32_32x32x16_bf16 v[32:47], v[124:127], v[60:63], v[32:47]
    ds_read_b128 v[60:63], v4 offset:36864
    s_waitcnt lgkmcnt(3)
    v_mfma_f32_32x32x16_bf16 v[16:31], v[128:131], v[48:51], v[16:31]
    ds_read_b128 v[48:51], v4 offset:37888
    s_waitcnt lgkmcnt(3)
    v_mfma_f32_32x32x16_bf16 v[16:31], v[132:135], v[52:55], v[16:31]
    ds_read_b128 v[52:55], v4 offset:38912
    s_waitcnt lgkmcnt(3)
    v_mfma_f32_32x32x16_bf16 v[16:31], v[136:139], v[56:59], v[16:31]
    s_waitcnt lgkmcnt(2)
    v_mfma_f32_32x32x16_bf16 v[32:47], v[128:131], v[60:63], v[32:47]
    s_waitcnt lgkmcnt(1)
    v_mfma_f32_32x32x16_bf16 v[32:47], v[132:135], v[48:51], v[32:47]
    s_waitcnt lgkmcnt(0)
    v_mfma_f32_32x32x16_bf16 v[32:47], v[136:139], v[52:55], v[32:47]
    s_nop 5
    ds_write_b128 v240, v[16:19] offset:0
    ds_write_b128 v241, v[20:23] offset:0
    ds_write_b128 v242, v[24:27] offset:0
    ds_write_b128 v243, v[28:31] offset:0
    s_nop 1
    ds_write_b128 v240, v[32:35] offset:8192
    ds_write_b128 v241, v[36:39] offset:8192
    ds_write_b128 v242, v[40:43] offset:8192
    ds_write_b128 v243, v[44:47] offset:8192
    s_waitcnt lgkmcnt(0)
    s_branch L_p5_done
L_p4_a:
    ds_read_b64_tr_b16 v[160:161], v9 offset:0
    ds_read_b64_tr_b16 v[162:163], v9 offset:512
    ds_read_b64_tr_b16 v[164:165], v9 offset:2048
    ds_read_b64_tr_b16 v[166:167], v9 offset:2560
    ds_read_b64_tr_b16 v[168:169], v9 offset:4096
    ds_read_b64_tr_b16 v[170:171], v9 offset:4608
    ds_read_b64_tr_b16 v[172:173], v9 offset:6144
    ds_read_b64_tr_b16 v[174:175], v9 offset:6656
    ds_read_b64_tr_b16 v[176:177], v9 offset:8192
    ds_read_b64_tr_b16 v[178:179], v9 offset:8704
    ds_read_b64_tr_b16 v[180:181], v9 offset:10240
    ds_read_b64_tr_b16 v[182:183], v9 offset:10752
    ds_read_b64_tr_b16 v[184:185], v9 offset:12288
    ds_read_b64_tr_b16 v[186:187], v9 offset:12800
    ds_read_b64_tr_b16 v[188:189], v9 offset:14336
    ds_read_b64_tr_b16 v[190:191], v9 offset:14848
    s_lshr_b32 s72, s71, 1
    s_min_u32 s72, s72, 18
    s_lshl_b32 s72, s72, 5
    s_add_u32 s99, s72, 32768
    s_mov_b32 exec_hi, 0
    buffer_load_dword v247, v249, s[28:31], s99 offen sc1
    s_mov_b32 exec_hi, -1
    s_and_b32 s72, s3, 1
    s_lshl_b32 s72, s72, 15
    v_bfe_u32 v10, v1, 3, 2
    v_lshlrev_b32 v10, 13, v10
    v_and_b32 v11, 7, v1
    v_lshl_add_u32 v10, v11, 7, v10
    v_add_u32 v10, s72, v10
    v_bfe_u32 v11, v1, 1, 3
    v_lshrrev_b32 v4, 5, v1
    v_xor_b32 v11, v11, v4
    v_xor_b32 v4, 0, v11
    v_lshl_add_u32 v4, v4, 4, v10
    v_xor_b32 v5, 2, v11
    v_lshl_add_u32 v5, v5, 4, v10
    v_xor_b32 v6, 4, v11
    v_lshl_add_u32 v6, v6, 4, v10
    v_xor_b32 v7, 6, v11
    v_lshl_add_u32 v7, v7, 4, v10
    v_and_b32 v10, 0x13, v1
    v_bfe_u32 v11, v1, 2, 1
    v_lshl_add_u32 v10, v11, 3, v10
    v_bfe_u32 v11, v1, 3, 1
    v_lshl_add_u32 v10, v11, 2, v10
    v_lshrrev_b32 v11, 5, v1
    v_mul_u32_u24 v11, 22528, v11
    v_lshl_add_u32 v10, v10, 2, v11
    s_lshr_b32 s72, s3, 1
    s_add_u32 s72, s72, s71
    s_lshl_b32 s72, s72, 7
    s_add_u32 s72, s72, 393216
    s_waitcnt vmcnt(1) lgkmcnt(0)
    s_mov_b32 exec_lo, 0x01010101
    s_mov_b32 exec_hi, 0x01010101
    buffer_load_dword v251, v2, s[28:31], s74 offen sc1
    s_mov_b64 exec, 1
    buffer_load_dword v251, v41, s[28:31], s78 offen sc1
    s_mov_b64 exec, -1
    s_barrier
    s_waitcnt vmcnt(2)
    v_cmp_eq_u32 vcc, v247, v248
    s_nop 0
    s_and_b32 s79, vcc_lo, 0xffffffff
    s_cmp_eq_u32 s79, 0xffffffff
    s_cbranch_scc1 L_skip_37
    s_mov_b32 exec_hi, 0
    s_mov_b32 exec_lo, 0xffffffff
    s_mov_b32 s93, 0
L_poll_38:
    buffer_load_dword v247, v249, s[28:31], s99 offen offset:0 sc1
    s_add_u32 s93, s93, 1
    s_waitcnt vmcnt(0)
    v_cmp_eq_u32 vcc, v247, v248
    s_cmp_gt_u32 s93, 200000
    s_cbranch_scc1 L_done_39
    s_cmp_eq_u64 vcc, exec
    s_cbranch_scc0 L_poll_38
L_done_39:
    s_mov_b64 exec, -1
L_skip_37:
    buffer_load_dword v192, v10, s[28:31], s72 offen offset:0 sc1
    buffer_load_dword v196, v10, s[28:31], s72 offen offset:256 sc1
    buffer_load_dword v200, v10, s[28:31], s72 offen offset:512 sc1
    s_add_u32 s72, s72, 5632
    buffer_load_dword v193, v10, s[28:31], s72 offen offset:0 sc1
    buffer_load_dword v197, v10, s[28:31], s72 offen offset:256 sc1
    buffer_load_dword v201, v10, s[28:31], s72 offen offset:512 sc1
    s_add_u32 s72, s72, 5632
    buffer_load_dword v194, v10, s[28:31], s72 offen offset:0 sc1
    buffer_load_dword v198, v10, s[28:31], s72 offen offset:256 sc1
    buffer_load_dword v202, v10, s[28:31], s72 offen offset:512 sc1
    s_add_u32 s72, s72, 5632
    buffer_load_dword v195, v10, s[28:31], s72 offen offset:0 sc1
    buffer_load_dword v199, v10, s[28:31], s72 offen offset:256 sc1
    buffer_load_dword v203, v10, s[28:31], s72 offen offset:512 sc1
    s_add_u32 s72, s72, 5632
    s_add_u32 s99, s60, 6946816
    s_lshl_b32 s79, s69, 2
    s_add_u32 s98, s60, s79
    s_add_u32 s98, s98, 6946816
    s_and_b32 s72, s3, 1
    s_lshl_b32 s79, s72, 8
    s_add_u32 s77, s77, s79
    s_mul_i32 s72, s72, 180224
    s_add_u32 s72, s72, s60
    s_add_u32 s72, s72, 6553600
    s_lshr_b32 s73, s3, 1
    s_add_u32 s101, s73, 4
    s_lshl_b32 s79, s69, 2
    s_sub_u32 s74, s71, s79
    s_add_u32 s74, s74, s73
    s_and_b32 s79, s74, 0xfc
    s_add_u32 s74, s74, s79
    s_lshl_b32 s74, s74, 11
    s_add_u32 s74, s74, s72
    s_add_u32 s88, s74, 131072
    s_lshl_b32 s74, s69, 1
    s_add_u32 s74, s74, s73
    s_and_b32 s79, s74, 0xfc
    s_add_u32 s74, s74, s79
    s_lshl_b32 s74, s74, 11
    s_add_u32 s86, s74, s72
    s_add_u32 s87, s86, 65536
    v_and_b32 v10, 31, v1
    v_lshlrev_b32 v10, 3, v10
    v_lshrrev_b32 v11, 5, v1
    v_lshl_add_u32 v235, v11, 11, v10
    v_lshlrev_b32 v3, 7, v1
    v_mov_b32 v10, 0x409d30fc
    v_mov_b32 v11, v10
    v_mov_b32 v14, 1.0
    v_mov_b32 v15, 1.0
    s_barrier
    buffer_load_dwordx2 v[208:209], v235, s[28:31], s77 offen offset:0 sc1
    buffer_load_dwordx2 v[210:211], v235, s[28:31], s77 offen offset:512 sc1
    buffer_load_dwordx2 v[212:213], v235, s[28:31], s77 offen offset:1024 sc1
    buffer_load_dwordx2 v[214:215], v235, s[28:31], s77 offen offset:1536 sc1
    s_waitcnt vmcnt(4)
    v_add_f32 v192, v192, v193
    v_add_f32 v194, v194, v195
    v_add_f32 v196, v196, v197
    v_add_f32 v198, v198, v199
    v_add_f32 v200, v200, v201
    v_add_f32 v202, v202, v203
    v_add_f32 v192, v192, v194
    v_add_f32 v196, v196, v198
    v_add_f32 v200, v200, v202
    v_mov_b32 v193, v192
    v_mov_b32 v197, v196
    v_mov_b32 v201, v200
    s_nop 1
    v_permlane32_swap_b32 v192, v193
    v_permlane32_swap_b32 v196, v197
    v_permlane32_swap_b32 v200, v201
    s_nop 1
    v_add_f32 v192, v192, v193
    v_and_b32 v193, 0xffff0000, v192
    v_sub_f32 v192, v192, v193
    v_cvt_pk_bf16_f32 v224, v193, v193
    v_cvt_pk_bf16_f32 v225, v192, v192
    v_lshl_or_b32 v226, v232, 16, v232
    v_mov_b32 v227, 0
    v_add_f32 v196, v196, v197
    v_and_b32 v197, 0xffff0000, v196
    v_sub_f32 v196, v196, v197
    v_cvt_pk_bf16_f32 v228, v197, v197
    v_cvt_pk_bf16_f32 v229, v196, v196
    v_lshl_or_b32 v230, v233, 16, v233
    v_mov_b32 v231, 0
    v_add_f32 v200, v200, v201
    v_and_b32 v201, 0xffff0000, v200
    v_sub_f32 v200, v200, v201
    v_cvt_pk_bf16_f32 v216, v201, v201
    v_cvt_pk_bf16_f32 v217, v200, v200
    v_lshl_or_b32 v218, v234, 16, v234
    v_mov_b32 v219, 0
    v_mov_b32 v235, 0
    s_waitcnt vmcnt(0) lgkmcnt(0)
    s_barrier
    ds_read_b128 v[16:19], v4 offset:0
    ds_read_b128 v[20:23], v5 offset:0
    ds_read_b128 v[24:27], v6 offset:0
    ds_read_b128 v[28:31], v7 offset:0
    s_waitcnt lgkmcnt(3)
    v_mfma_f32_32x32x16_bf16 v[192:207], v[64:67], v[16:19], 0
    ds_read_b128 v[32:35], v4 offset:1024
    v_add_f32 v208, v208, v210
    v_add_f32 v209, v209, v211
    s_waitcnt lgkmcnt(3)
    v_mfma_f32_32x32x16_bf16 v[192:207], v[68:71], v[20:23], v[192:207]
    ds_read_b128 v[36:39], v5 offset:1024
    v_add_f32 v212, v212, v214
    s_waitcnt lgkmcnt(3)
    v_mfma_f32_32x32x16_bf16 v[192:207], v[72:75], v[24:27], v[192:207]
    ds_read_b128 v[40:43], v6 offset:1024
    v_add_f32 v213, v213, v215
    v_add_f32 v208, v208, v212
    s_waitcnt lgkmcnt(3)
    v_mfma_f32_32x32x16_bf16 v[192:207], v[76:79], v[28:31], v[192:207]
    ds_read_b128 v[44:47], v7 offset:1024
    v_add_f32 v209, v209, v213
    s_waitcnt lgkmcnt(3)
    v_mfma_f32_32x32x16_bf16 v[192:207], v[80:83], v[32:35], v[192:207]
    s_barrier
    ds_read_b128 v[48:51], v4 offset:2048
    v_mov_b32 v210, v208
    v_mov_b32 v211, v209
    s_waitcnt lgkmcnt(3)
    v_mfma_f32_32x32x16_bf16 v[192:207], v[84:87], v[36:39], v[192:207]
    ds_read_b128 v[52:55], v5 offset:2048
    s_nop 1
    v_permlane32_swap_b32 v208, v210
    s_waitcnt lgkmcnt(3)
    v_mfma_f32_32x32x16_bf16 v[192:207], v[88:91], v[40:43], v[192:207]
    ds_read_b128 v[56:59], v6 offset:2048
    v_permlane32_swap_b32 v209, v211
    s_nop 1
    v_add_f32 v208, v208, v210
    s_waitcnt lgkmcnt(3)
    v_mfma_f32_32x32x16_bf16 v[192:207], v[92:95], v[44:47], v[192:207]
    ds_read_b128 v[60:63], v7 offset:2048
    v_add_f32 v209, v209, v211
    s_waitcnt lgkmcnt(3)
    v_mfma_f32_32x32x16_bf16 v[192:207], v[96:99], v[48:51], v[192:207]
    ds_read_b128 v[64:67], v4 offset:3072
    v_mul_f32 v208, 0xbb000000, v208
    v_mul_f32 v209, 0x3b000000, v209
    s_waitcnt lgkmcnt(3)
    v_mfma_f32_32x32x16_bf16 v[192:207], v[100:103], v[52:55], v[192:207]
    ds_read_b128 v[68:71], v5 offset:3072
    v_fma_f32 v209, -v208, v208, v209
    s_waitcnt lgkmcnt(3)
    v_mfma_f32_32x32x16_bf16 v[192:207], v[104:107], v[56:59], v[192:207]
    ds_read_b128 v[72:75], v6 offset:3072
    v_max_f32 v209, 0, v209
    s_waitcnt lgkmcnt(3)
    v_mfma_f32_32x32x16_bf16 v[192:207], v[108:111], v[60:63], v[192:207]
    ds_read_b128 v[76:79], v7 offset:3072
    v_add_f32 v209, 0x3727c5ac, v209
    v_rsq_f32 v210, v209
    s_waitcnt lgkmcnt(3)
    v_mfma_f32_32x32x16_bf16 v[192:207], v[112:115], v[64:67], v[192:207]
    s_barrier
    ds_read_b128 v[80:83], v4 offset:4096
    v_and_b32 v211, 0xffff0000, v208
    s_waitcnt lgkmcnt(3)
    v_mfma_f32_32x32x16_bf16 v[192:207], v[116:119], v[68:71], v[192:207]
    ds_read_b128 v[84:87], v5 offset:4096
    v_sub_f32 v208, v208, v211
    v_mul_f32 v209, v209, v210
    s_waitcnt lgkmcnt(3)
    v_mfma_f32_32x32x16_bf16 v[192:207], v[120:123], v[72:75], v[192:207]
    ds_read_b128 v[88:91], v6 offset:4096
    v_mul_f32 v12, 0xbeeff558, v210
    s_waitcnt lgkmcnt(3)
    v_mfma_f32_32x32x16_bf16 v[192:207], v[124:127], v[76:79], v[192:207]
    ds_read_b128 v[92:95], v7 offset:4096
    v_cvt_pk_bf16_f32 v232, v211, v208
    v_and_b32 v211, 0xffff0000, v209
    s_waitcnt lgkmcnt(3)
    v_mfma_f32_32x32x16_bf16 v[192:207], v[128:131], v[80:83], v[192:207]
    ds_read_b128 v[96:99], v4 offset:5120
    v_sub_f32 v209, v209, v211
    s_waitcnt lgkmcnt(3)
    v_mfma_f32_32x32x16_bf16 v[192:207], v[132:135], v[84:87], v[192:207]
    ds_read_b128 v[100:103], v5 offset:5120
    v_mov_b32 v13, v12
    v_cvt_pk_bf16_f32 v234, v211, v209
    s_waitcnt lgkmcnt(3)
    v_mfma_f32_32x32x16_bf16 v[192:207], v[136:139], v[88:91], v[192:207]
    ds_read_b128 v[104:107], v6 offset:5120
    s_mov_b32 exec_lo, 0
    v_mov_b32 v232, 0
    v_mov_b32 v234, 0
    s_mov_b32 exec_lo, -1
    s_waitcnt lgkmcnt(3)
    v_mfma_f32_32x32x16_bf16 v[192:207], v[140:143], v[92:95], v[192:207]
    ds_read_b128 v[108:111], v7 offset:5120
    v_mov_b32 v233, v232
    s_waitcnt lgkmcnt(3)
    v_mfma_f32_32x32x16_bf16 v[192:207], v[144:147], v[96:99], v[192:207]
    s_barrier
    ds_read_b128 v[112:115], v4 offset:6144
    s_waitcnt lgkmcnt(3)
    v_mfma_f32_32x32x16_bf16 v[192:207], v[148:151], v[100:103], v[192:207]
    ds_read_b128 v[116:119], v5 offset:6144
    s_waitcnt lgkmcnt(3)
    v_mfma_f32_32x32x16_bf16 v[192:207], v[152:155], v[104:107], v[192:207]
    ds_read_b128 v[120:123], v6 offset:6144
    s_waitcnt lgkmcnt(3)
    v_mfma_f32_32x32x16_bf16 v[192:207], v[156:159], v[108:111], v[192:207]
    ds_read_b128 v[124:127], v7 offset:6144
    v_mfma_f32_32x32x16_bf16 v[192:207], v[224:227], v[232:235], v[192:207]
    s_waitcnt lgkmcnt(3)
    v_mfma_f32_32x32x16_bf16 v[192:207], v[160:163], v[112:115], v[192:207]
    ds_read_b128 v[128:131], v4 offset:7168
    s_waitcnt lgkmcnt(3)
    v_mfma_f32_32x32x16_bf16 v[192:207], v[164:167], v[116:119], v[192:207]
    ds_read_b128 v[132:135], v5 offset:7168
    s_waitcnt lgkmcnt(3)
    v_mfma_f32_32x32x16_bf16 v[192:207], v[168:171], v[120:123], v[192:207]
    ds_read_b128 v[136:139], v6 offset:7168
    s_waitcnt lgkmcnt(3)
    v_mfma_f32_32x32x16_bf16 v[192:207], v[172:175], v[124:127], v[192:207]
    ds_read_b128 v[140:143], v7 offset:7168
    s_waitcnt lgkmcnt(3)
    v_mfma_f32_32x32x16_bf16 v[192:207], v[176:179], v[128:131], v[192:207]
    ds_read_b64_tr_b16 v[152:153], v9 offset:16384
    ds_read_b64_tr_b16 v[154:155], v9 offset:16896
    ds_read_b64_tr_b16 v[156:157], v9 offset:18432
    ds_read_b64_tr_b16 v[158:159], v9 offset:18944
    s_waitcnt lgkmcnt(6)
    v_mfma_f32_32x32x16_bf16 v[192:207], v[180:183], v[132:135], v[192:207]
    ds_read_b64_tr_b16 v[160:161], v9 offset:20480
    ds_read_b64_tr_b16 v[162:163], v9 offset:20992
    ds_read_b64_tr_b16 v[164:165], v9 offset:22528
    ds_read_b64_tr_b16 v[166:167], v9 offset:23040
    s_waitcnt lgkmcnt(9)
    v_mfma_f32_32x32x16_bf16 v[192:207], v[184:187], v[136:139], v[192:207]
    ds_read_b64_tr_b16 v[144:145], v9 offset:24576
    ds_read_b64_tr_b16 v[146:147], v9 offset:25088
    s_waitcnt lgkmcnt(10)
    v_mfma_f32_32x32x16_bf16 v[192:207], v[188:191], v[140:143], v[192:207]
    ds_read_b64_tr_b16 v[148:149], v9 offset:26624
    ds_read_b64_tr_b16 v[150:151], v9 offset:27136
    v_mfma_f32_32x32x16_bf16 v[168:183], v[216:219], v[232:235], 0
    v_mfma_f32_32x32x16_bf16 v[208:223], v[228:231], v[232:235], 0
    s_nop 7
.p2align 3
    v_pk_mul_f32 v[192:193], v[192:193], v[12:13]
    v_pk_mul_f32 v[194:195], v[194:195], v[12:13]
    v_pk_mul_f32 v[196:197], v[196:197], v[12:13]
    v_pk_mul_f32 v[198:199], v[198:199], v[12:13]
    v_pk_mul_f32 v[200:201], v[200:201], v[12:13]
    v_pk_mul_f32 v[202:203], v[202:203], v[12:13]
    v_pk_mul_f32 v[204:205], v[204:205], v[12:13]
    v_pk_mul_f32 v[206:207], v[206:207], v[12:13]
    v_pk_fma_f32 v[224:225], v[192:193], v[192:193], v[10:11]
    v_pk_fma_f32 v[226:227], v[194:195], v[194:195], v[10:11]
    v_pk_fma_f32 v[228:229], v[196:197], v[196:197], v[10:11]
    v_pk_fma_f32 v[230:231], v[198:199], v[198:199], v[10:11]
    v_pk_fma_f32 v[184:185], v[200:201], v[200:201], v[10:11]
    v_pk_fma_f32 v[186:187], v[202:203], v[202:203], v[10:11]
    v_pk_fma_f32 v[188:189], v[204:205], v[204:205], v[10:11]
    v_pk_fma_f32 v[190:191], v[206:207], v[206:207], v[10:11]
    v_pk_mul_f32 v[224:225], v[224:225], v[192:193]
    v_pk_mul_f32 v[226:227], v[226:227], v[194:195]
    v_pk_mul_f32 v[228:229], v[228:229], v[196:197]
    v_pk_mul_f32 v[230:231], v[230:231], v[198:199]
    v_pk_mul_f32 v[184:185], v[184:185], v[200:201]
    v_pk_mul_f32 v[186:187], v[186:187], v[202:203]
    v_pk_mul_f32 v[188:189], v[188:189], v[204:205]
    v_pk_mul_f32 v[190:191], v[190:191], v[206:207]
    v_exp_f32 v224, v224
    v_exp_f32 v225, v225
    v_exp_f32 v226, v226
    v_exp_f32 v227, v227
    v_exp_f32 v228, v228
    v_exp_f32 v229, v229
    v_exp_f32 v230, v230
    v_exp_f32 v231, v231
    v_exp_f32 v184, v184
    v_exp_f32 v185, v185
    v_exp_f32 v186, v186
    v_exp_f32 v187, v187
    v_exp_f32 v188, v188
    v_exp_f32 v189, v189
    v_exp_f32 v190, v190
    v_exp_f32 v191, v191
    v_pk_add_f32 v[224:225], v[224:225], v[14:15]
    v_pk_add_f32 v[226:227], v[226:227], v[14:15]
    v_pk_add_f32 v[228:229], v[228:229], v[14:15]
    v_pk_add_f32 v[230:231], v[230:231], v[14:15]
    v_pk_add_f32 v[184:185], v[184:185], v[14:15]
    v_pk_add_f32 v[186:187], v[186:187], v[14:15]
    v_pk_add_f32 v[188:189], v[188:189], v[14:15]
    v_pk_add_f32 v[190:191], v[190:191], v[14:15]
    v_rcp_f32 v224, v224
    v_rcp_f32 v225, v225
    v_rcp_f32 v226, v226
    v_rcp_f32 v227, v227
    v_rcp_f32 v228, v228
    v_rcp_f32 v229, v229
    v_rcp_f32 v230, v230
    v_rcp_f32 v231, v231
    v_pk_mul_f32 v[224:225], v[224:225], v[192:193]
    v_pk_mul_f32 v[226:227], v[226:227], v[194:195]
    v_pk_mul_f32 v[228:229], v[228:229], v[196:197]
    v_pk_mul_f32 v[230:231], v[230:231], v[198:199]
    v_cvt_pk_bf16_f32 v192, v224, v225
    v_cvt_pk_bf16_f32 v193, v226, v227
    v_cvt_pk_bf16_f32 v194, v228, v229
    v_cvt_pk_bf16_f32 v195, v230, v231
    buffer_store_dwordx4 v[192:195], v246, s[28:31], s86 offen offset:0 sc1
    v_rcp_f32 v184, v184
    v_rcp_f32 v185, v185
    v_rcp_f32 v186, v186
    v_rcp_f32 v187, v187
    v_rcp_f32 v188, v188
    v_rcp_f32 v189, v189
    v_rcp_f32 v190, v190
    v_rcp_f32 v191, v191
    v_pk_mul_f32 v[184:185], v[184:185], v[200:201]
    v_pk_mul_f32 v[186:187], v[186:187], v[202:203]
    v_pk_mul_f32 v[188:189], v[188:189], v[204:205]
    v_pk_mul_f32 v[190:191], v[190:191], v[206:207]
    v_cvt_pk_bf16_f32 v200, v184, v185
    v_cvt_pk_bf16_f32 v201, v186, v187
    v_cvt_pk_bf16_f32 v202, v188, v189
    v_cvt_pk_bf16_f32 v203, v190, v191
    buffer_store_dwordx4 v[200:203], v246, s[28:31], s86 offen offset:1024 sc1
    s_waitcnt lgkmcnt(8)
    v_mfma_f32_32x32x16_bf16 v[208:223], v[152:155], v[16:19], v[208:223]
    ds_read_b64_tr_b16 v[152:153], v9 offset:28672
    ds_read_b64_tr_b16 v[154:155], v9 offset:29184
    v_mfma_f32_32x32x16_bf16 v[208:223], v[156:159], v[20:23], v[208:223]
    ds_read_b64_tr_b16 v[156:157], v9 offset:30720
    ds_read_b64_tr_b16 v[158:159], v9 offset:31232
    s_waitcnt lgkmcnt(8)
    v_mfma_f32_32x32x16_bf16 v[208:223], v[160:163], v[24:27], v[208:223]
    ds_read_b64_tr_b16 v[160:161], v9 offset:32768
    ds_read_b64_tr_b16 v[162:163], v9 offset:33280
    v_mfma_f32_32x32x16_bf16 v[208:223], v[164:167], v[28:31], v[208:223]
    ds_read_b64_tr_b16 v[164:165], v9 offset:34816
    ds_read_b64_tr_b16 v[166:167], v9 offset:35328
    s_waitcnt lgkmcnt(8)
    v_mfma_f32_32x32x16_bf16 v[208:223], v[144:147], v[32:35], v[208:223]
    ds_read_b64_tr_b16 v[144:145], v9 offset:36864
    ds_read_b64_tr_b16 v[146:147], v9 offset:37376
    v_mfma_f32_32x32x16_bf16 v[208:223], v[148:151], v[36:39], v[208:223]
    ds_read_b64_tr_b16 v[148:149], v9 offset:38912
    ds_read_b64_tr_b16 v[150:151], v9 offset:39424
    s_waitcnt lgkmcnt(8)
    v_mfma_f32_32x32x16_bf16 v[208:223], v[152:155], v[40:43], v[208:223]
    ds_read_b64_tr_b16 v[152:153], v9 offset:40960
    ds_read_b64_tr_b16 v[154:155], v9 offset:41472
    v_mfma_f32_32x32x16_bf16 v[208:223], v[156:159], v[44:47], v[208:223]
    ds_read_b64_tr_b16 v[156:157], v9 offset:43008
    ds_read_b64_tr_b16 v[158:159], v9 offset:43520
    s_waitcnt lgkmcnt(8)
    v_mfma_f32_32x32x16_bf16 v[208:223], v[160:163], v[48:51], v[208:223]
    ds_read_b64_tr_b16 v[160:161], v9 offset:45056
    ds_read_b64_tr_b16 v[162:163], v9 offset:45568
    v_mfma_f32_32x32x16_bf16 v[208:223], v[164:167], v[52:55], v[208:223]
    ds_read_b64_tr_b16 v[164:165], v9 offset:47104
    ds_read_b64_tr_b16 v[166:167], v9 offset:47616
    s_waitcnt lgkmcnt(8)
    v_mfma_f32_32x32x16_bf16 v[208:223], v[144:147], v[56:59], v[208:223]
    s_barrier
    ds_read_b64_tr_b16 v[144:145], v8 offset:0
    ds_read_b64_tr_b16 v[146:147], v8 offset:512
    v_mfma_f32_32x32x16_bf16 v[208:223], v[148:151], v[60:63], v[208:223]
    ds_read_b64_tr_b16 v[148:149], v8 offset:2048
    ds_read_b64_tr_b16 v[150:151], v8 offset:2560
    s_waitcnt lgkmcnt(8)
    v_mfma_f32_32x32x16_bf16 v[208:223], v[152:155], v[64:67], v[208:223]
    ds_read_b64_tr_b16 v[152:153], v8 offset:4096
    ds_read_b64_tr_b16 v[154:155], v8 offset:4608
    v_mfma_f32_32x32x16_bf16 v[208:223], v[156:159], v[68:71], v[208:223]
    ds_read_b64_tr_b16 v[156:157], v8 offset:6144
    ds_read_b64_tr_b16 v[158:159], v8 offset:6656
    s_waitcnt lgkmcnt(8)
    v_mfma_f32_32x32x16_bf16 v[208:223], v[160:163], v[72:75], v[208:223]
    ds_read_b64_tr_b16 v[160:161], v8 offset:8192
    ds_read_b64_tr_b16 v[162:163], v8 offset:8704
    v_mfma_f32_32x32x16_bf16 v[208:223], v[164:167], v[76:79], v[208:223]
    ds_read_b64_tr_b16 v[164:165], v8 offset:10240
    ds_read_b64_tr_b16 v[166:167], v8 offset:10752
    s_waitcnt lgkmcnt(8)
    v_mfma_f32_32x32x16_bf16 v[208:223], v[144:147], v[80:83], v[208:223]
    ds_read_b64_tr_b16 v[144:145], v8 offset:12288
    ds_read_b64_tr_b16 v[146:147], v8 offset:12800
    v_mfma_f32_32x32x16_bf16 v[208:223], v[148:151], v[84:87], v[208:223]
    ds_read_b64_tr_b16 v[148:149], v8 offset:14336
    ds_read_b64_tr_b16 v[150:151], v8 offset:14848
    s_waitcnt lgkmcnt(8)
    v_mfma_f32_32x32x16_bf16 v[208:223], v[152:155], v[88:91], v[208:223]
    s_barrier
    ds_read_b64_tr_b16 v[152:153], v8 offset:16384
    ds_read_b64_tr_b16 v[154:155], v8 offset:16896
    v_mfma_f32_32x32x16_bf16 v[208:223], v[156:159], v[92:95], v[208:223]
    ds_read_b64_tr_b16 v[156:157], v8 offset:18432
    ds_read_b64_tr_b16 v[158:159], v8 offset:18944
    s_waitcnt lgkmcnt(8)
    v_mfma_f32_32x32x16_bf16 v[208:223], v[160:163], v[96:99], v[208:223]
    ds_read_b64_tr_b16 v[160:161], v8 offset:20480
    ds_read_b64_tr_b16 v[162:163], v8 offset:20992
    v_mfma_f32_32x32x16_bf16 v[208:223], v[164:167], v[100:103], v[208:223]
    ds_read_b64_tr_b16 v[164:165], v8 offset:22528
    ds_read_b64_tr_b16 v[166:167], v8 offset:23040
    s_waitcnt lgkmcnt(8)
    v_mfma_f32_32x32x16_bf16 v[208:223], v[144:147], v[104:107], v[208:223]
    ds_read_b64_tr_b16 v[144:145], v8 offset:24576
    ds_read_b64_tr_b16 v[146:147], v8 offset:25088
    v_mfma_f32_32x32x16_bf16 v[208:223], v[148:151], v[108:111], v[208:223]
    ds_read_b64_tr_b16 v[148:149], v8 offset:26624
    ds_read_b64_tr_b16 v[150:151], v8 offset:27136
    s_waitcnt lgkmcnt(8)
    v_mfma_f32_32x32x16_bf16 v[208:223], v[152:155], v[112:115], v[208:223]
    ds_read_b64_tr_b16 v[152:153], v8 offset:28672
    ds_read_b64_tr_b16 v[154:155], v8 offset:29184
    v_mfma_f32_32x32x16_bf16 v[208:223], v[156:159], v[116:119], v[208:223]
    ds_read_b64_tr_b16 v[156:157], v8 offset:30720
    ds_read_b64_tr_b16 v[158:159], v8 offset:31232
    s_waitcnt lgkmcnt(8)
    v_mfma_f32_32x32x16_bf16 v[208:223], v[160:163], v[120:123], v[208:223]
    ds_read_b64_tr_b16 v[160:161], v8 offset:32768
    ds_read_b64_tr_b16 v[162:163], v8 offset:33280
    v_mfma_f32_32x32x16_bf16 v[208:223], v[164:167], v[124:127], v[208:223]
    ds_read_b64_tr_b16 v[164:165], v8 offset:34816
    ds_read_b64_tr_b16 v[166:167], v8 offset:35328
    s_waitcnt lgkmcnt(8)
    v_mfma_f32_32x32x16_bf16 v[208:223], v[144:147], v[128:131], v[208:223]
    ds_read_b64_tr_b16 v[144:145], v8 offset:36864
    ds_read_b64_tr_b16 v[146:147], v8 offset:37376
    s_waitcnt vmcnt(0)
    s_barrier
    v_mfma_f32_32x32x16_bf16 v[208:223], v[148:151], v[132:135], v[208:223]
    ds_read_b64_tr_b16 v[148:149], v8 offset:38912
    ds_read_b64_tr_b16 v[150:151], v8 offset:39424
    s_waitcnt lgkmcnt(8)
    v_mfma_f32_32x32x16_bf16 v[208:223], v[152:155], v[136:139], v[208:223]
    ds_read_b64_tr_b16 v[152:153], v8 offset:40960
    ds_read_b64_tr_b16 v[154:155], v8 offset:41472
    v_mfma_f32_32x32x16_bf16 v[208:223], v[156:159], v[140:143], v[208:223]
    ds_read_b64_tr_b16 v[156:157], v8 offset:43008
    ds_read_b64_tr_b16 v[158:159], v8 offset:43520
    s_nop 7
    s_nop 1
.p2align 3
    v_pk_mul_f32 v[208:209], v[208:209], v[12:13]
    v_pk_mul_f32 v[210:211], v[210:211], v[12:13]
    v_pk_mul_f32 v[212:213], v[212:213], v[12:13]
    v_pk_mul_f32 v[214:215], v[214:215], v[12:13]
    v_pk_mul_f32 v[216:217], v[216:217], v[12:13]
    v_pk_mul_f32 v[218:219], v[218:219], v[12:13]
    v_pk_mul_f32 v[220:221], v[220:221], v[12:13]
    v_pk_mul_f32 v[222:223], v[222:223], v[12:13]
    v_pk_fma_f32 v[224:225], v[208:209], v[208:209], v[10:11]
    v_pk_fma_f32 v[226:227], v[210:211], v[210:211], v[10:11]
    v_pk_fma_f32 v[228:229], v[212:213], v[212:213], v[10:11]
    v_pk_fma_f32 v[230:231], v[214:215], v[214:215], v[10:11]
    v_pk_fma_f32 v[184:185], v[216:217], v[216:217], v[10:11]
    v_pk_fma_f32 v[186:187], v[218:219], v[218:219], v[10:11]
    v_pk_fma_f32 v[188:189], v[220:221], v[220:221], v[10:11]
    v_pk_fma_f32 v[190:191], v[222:223], v[222:223], v[10:11]
    v_pk_mul_f32 v[224:225], v[224:225], v[208:209]
    v_pk_mul_f32 v[226:227], v[226:227], v[210:211]
    v_pk_mul_f32 v[228:229], v[228:229], v[212:213]
    v_pk_mul_f32 v[230:231], v[230:231], v[214:215]
    v_pk_mul_f32 v[184:185], v[184:185], v[216:217]
    v_pk_mul_f32 v[186:187], v[186:187], v[218:219]
    v_pk_mul_f32 v[188:189], v[188:189], v[220:221]
    v_pk_mul_f32 v[190:191], v[190:191], v[222:223]
    v_exp_f32 v224, v224
    v_exp_f32 v225, v225
    v_exp_f32 v226, v226
    v_exp_f32 v227, v227
    v_exp_f32 v228, v228
    v_exp_f32 v229, v229
    v_exp_f32 v230, v230
    v_exp_f32 v231, v231
    v_exp_f32 v184, v184
    v_exp_f32 v185, v185
    v_exp_f32 v186, v186
    v_exp_f32 v187, v187
    v_exp_f32 v188, v188
    v_exp_f32 v189, v189
    v_exp_f32 v190, v190
    v_exp_f32 v191, v191
    v_pk_add_f32 v[224:225], v[224:225], v[14:15]
    v_pk_add_f32 v[226:227], v[226:227], v[14:15]
    v_pk_add_f32 v[228:229], v[228:229], v[14:15]
    v_pk_add_f32 v[230:231], v[230:231], v[14:15]
    v_pk_add_f32 v[184:185], v[184:185], v[14:15]
    v_pk_add_f32 v[186:187], v[186:187], v[14:15]
    v_pk_add_f32 v[188:189], v[188:189], v[14:15]
    v_pk_add_f32 v[190:191], v[190:191], v[14:15]
    v_rcp_f32 v224, v224
    v_rcp_f32 v225, v225
    v_rcp_f32 v226, v226
    v_rcp_f32 v227, v227
    v_rcp_f32 v228, v228
    v_rcp_f32 v229, v229
    v_rcp_f32 v230, v230
    v_rcp_f32 v231, v231
    v_pk_mul_f32 v[224:225], v[224:225], v[208:209]
    v_pk_mul_f32 v[226:227], v[226:227], v[210:211]
    v_pk_mul_f32 v[228:229], v[228:229], v[212:213]
    v_pk_mul_f32 v[230:231], v[230:231], v[214:215]
    v_cvt_pk_bf16_f32 v208, v224, v225
    v_cvt_pk_bf16_f32 v209, v226, v227
    v_cvt_pk_bf16_f32 v210, v228, v229
    v_cvt_pk_bf16_f32 v211, v230, v231
    buffer_store_dwordx4 v[208:211], v246, s[28:31], s87 offen offset:0 sc1
    v_rcp_f32 v184, v184
    v_rcp_f32 v185, v185
    v_rcp_f32 v186, v186
    v_rcp_f32 v187, v187
    v_rcp_f32 v188, v188
    v_rcp_f32 v189, v189
    v_rcp_f32 v190, v190
    v_rcp_f32 v191, v191
    v_pk_mul_f32 v[184:185], v[184:185], v[216:217]
    v_pk_mul_f32 v[186:187], v[186:187], v[218:219]
    v_pk_mul_f32 v[188:189], v[188:189], v[220:221]
    v_pk_mul_f32 v[190:191], v[190:191], v[222:223]
    v_cvt_pk_bf16_f32 v216, v184, v185
    v_cvt_pk_bf16_f32 v217, v186, v187
    v_cvt_pk_bf16_f32 v218, v188, v189
    v_cvt_pk_bf16_f32 v219, v190, v191
    buffer_store_dwordx4 v[216:219], v246, s[28:31], s87 offen offset:1024 sc1
    s_cmp_ge_u32 s101, s92
    s_cbranch_scc1 L_p4_idle
    s_waitcnt lgkmcnt(8)
    v_mfma_f32_32x32x16_bf16 v[168:183], v[160:163], v[16:19], v[168:183]
    ds_read_b64_tr_b16 v[160:161], v8 offset:45056
    ds_read_b64_tr_b16 v[162:163], v8 offset:45568
    v_mfma_f32_32x32x16_bf16 v[168:183], v[164:167], v[20:23], v[168:183]
    ds_read_b64_tr_b16 v[164:165], v8 offset:47104
    ds_read_b64_tr_b16 v[166:167], v8 offset:47616
    s_waitcnt lgkmcnt(8)
    v_mfma_f32_32x32x16_bf16 v[168:183], v[144:147], v[24:27], v[168:183]
    ds_read_b64_tr_b16 v[144:145], v9 offset:0
    ds_read_b64_tr_b16 v[146:147], v9 offset:512
    v_mfma_f32_32x32x16_bf16 v[168:183], v[148:151], v[28:31], v[168:183]
    ds_read_b64_tr_b16 v[148:149], v9 offset:2048
    ds_read_b64_tr_b16 v[150:151], v9 offset:2560
    s_waitcnt lgkmcnt(8)
    v_mfma_f32_32x32x16_bf16 v[168:183], v[152:155], v[32:35], v[168:183]
    ds_read_b64_tr_b16 v[152:153], v9 offset:4096
    ds_read_b64_tr_b16 v[154:155], v9 offset:4608
    v_mfma_f32_32x32x16_bf16 v[168:183], v[156:159], v[36:39], v[168:183]
    ds_read_b64_tr_b16 v[156:157], v9 offset:6144
    ds_read_b64_tr_b16 v[158:159], v9 offset:6656
    s_waitcnt lgkmcnt(8)
    v_mfma_f32_32x32x16_bf16 v[168:183], v[160:163], v[40:43], v[168:183]
    ds_read_b64_tr_b16 v[160:161], v9 offset:8192
    ds_read_b64_tr_b16 v[162:163], v9 offset:8704
    s_and_b32 s72, s3, 3
    v_mfma_f32_32x32x16_bf16 v[168:183], v[164:167], v[44:47], v[168:183]
    ds_read_b64_tr_b16 v[164:165], v9 offset:10240
    ds_read_b64_tr_b16 v[166:167], v9 offset:10752
    s_waitcnt lgkmcnt(8)
    v_mfma_f32_32x32x16_bf16 v[168:183], v[144:147], v[48:51], v[168:183]
    ds_read_b64_tr_b16 v[144:145], v9 offset:12288
    ds_read_b64_tr_b16 v[146:147], v9 offset:12800
    s_lshl_b32 s75, s72, 10
    v_mfma_f32_32x32x16_bf16 v[168:183], v[148:151], v[52:55], v[168:183]
    ds_read_b64_tr_b16 v[148:149], v9 offset:14336
    ds_read_b64_tr_b16 v[150:151], v9 offset:14848
    s_waitcnt lgkmcnt(8)
    v_mfma_f32_32x32x16_bf16 v[168:183], v[152:155], v[56:59], v[168:183]
    s_barrier
    ds_read_b64_tr_b16 v[152:153], v9 offset:16384
    ds_read_b64_tr_b16 v[154:155], v9 offset:16896
    s_lshl_b32 s72, s72, 11
    v_mfma_f32_32x32x16_bf16 v[168:183], v[156:159], v[60:63], v[168:183]
    ds_read_b64_tr_b16 v[156:157], v9 offset:18432
    ds_read_b64_tr_b16 v[158:159], v9 offset:18944
    s_waitcnt lgkmcnt(8)
    v_mfma_f32_32x32x16_bf16 v[168:183], v[160:163], v[64:67], v[168:183]
    ds_read_b64_tr_b16 v[160:161], v9 offset:20480
    ds_read_b64_tr_b16 v[162:163], v9 offset:20992
    s_add_u32 s72, s72, s60
    v_mfma_f32_32x32x16_bf16 v[168:183], v[164:167], v[68:71], v[168:183]
    ds_read_b64_tr_b16 v[164:165], v9 offset:22528
    ds_read_b64_tr_b16 v[166:167], v9 offset:23040
    s_waitcnt lgkmcnt(8)
    v_mfma_f32_32x32x16_bf16 v[168:183], v[144:147], v[72:75], v[168:183]
    ds_read_b64_tr_b16 v[144:145], v9 offset:24576
    ds_read_b64_tr_b16 v[146:147], v9 offset:25088
    s_add_u32 s76, s72, 6553600
    v_mfma_f32_32x32x16_bf16 v[168:183], v[148:151], v[76:79], v[168:183]
    ds_read_b64_tr_b16 v[148:149], v9 offset:26624
    ds_read_b64_tr_b16 v[150:151], v9 offset:27136
    s_waitcnt lgkmcnt(8)
    v_mfma_f32_32x32x16_bf16 v[168:183], v[152:155], v[80:83], v[168:183]
    ds_read_b64_tr_b16 v[152:153], v9 offset:28672
    ds_read_b64_tr_b16 v[154:155], v9 offset:29184
    v_mfma_f32_32x32x16_bf16 v[168:183], v[156:159], v[84:87], v[168:183]
    ds_read_b64_tr_b16 v[156:157], v9 offset:30720
    ds_read_b64_tr_b16 v[158:159], v9 offset:31232
    s_waitcnt lgkmcnt(8)
    v_mfma_f32_32x32x16_bf16 v[168:183], v[160:163], v[88:91], v[168:183]
    ds_read_b64_tr_b16 v[160:161], v9 offset:32768
    ds_read_b64_tr_b16 v[162:163], v9 offset:33280
    v_mfma_f32_32x32x16_bf16 v[168:183], v[164:167], v[92:95], v[168:183]
    ds_read_b64_tr_b16 v[164:165], v9 offset:34816
    ds_read_b64_tr_b16 v[166:167], v9 offset:35328
    s_waitcnt lgkmcnt(8)
    v_mfma_f32_32x32x16_bf16 v[168:183], v[144:147], v[96:99], v[168:183]
    ds_read_b64_tr_b16 v[144:145], v9 offset:36864
    ds_read_b64_tr_b16 v[146:147], v9 offset:37376
    v_mfma_f32_32x32x16_bf16 v[168:183], v[148:151], v[100:103], v[168:183]
    ds_read_b64_tr_b16 v[148:149], v9 offset:38912
    ds_read_b64_tr_b16 v[150:151], v9 offset:39424
    s_waitcnt lgkmcnt(8)
    v_mfma_f32_32x32x16_bf16 v[168:183], v[152:155], v[104:107], v[168:183]
    ds_read_b64_tr_b16 v[152:153], v9 offset:40960
    ds_read_b64_tr_b16 v[154:155], v9 offset:41472
    v_mfma_f32_32x32x16_bf16 v[168:183], v[156:159], v[108:111], v[168:183]
    ds_read_b64_tr_b16 v[156:157], v9 offset:43008
    ds_read_b64_tr_b16 v[158:159], v9 offset:43520
    s_waitcnt lgkmcnt(8)
    v_mfma_f32_32x32x16_bf16 v[168:183], v[160:163], v[112:115], v[168:183]
    ds_read_b64_tr_b16 v[160:161], v9 offset:45056
    ds_read_b64_tr_b16 v[162:163], v9 offset:45568
    s_waitcnt vmcnt(0)
    s_barrier
    v_mfma_f32_32x32x16_bf16 v[168:183], v[164:167], v[116:119], v[168:183]
    ds_read_b64_tr_b16 v[164:165], v9 offset:47104
    ds_read_b64_tr_b16 v[166:167], v9 offset:47616
    s_waitcnt lgkmcnt(8)
    v_mfma_f32_32x32x16_bf16 v[168:183], v[144:147], v[120:123], v[168:183]
    v_mfma_f32_32x32x16_bf16 v[168:183], v[148:151], v[124:127], v[168:183]
    s_waitcnt lgkmcnt(4)
    v_mfma_f32_32x32x16_bf16 v[168:183], v[152:155], v[128:131], v[168:183]
    v_mfma_f32_32x32x16_bf16 v[168:183], v[156:159], v[132:135], v[168:183]
    s_waitcnt lgkmcnt(0)
    v_mfma_f32_32x32x16_bf16 v[168:183], v[160:163], v[136:139], v[168:183]
    v_mfma_f32_32x32x16_bf16 v[168:183], v[164:167], v[140:143], v[168:183]
    s_nop 7
    s_nop 3
.p2align 3
    v_pk_mul_f32 v[168:169], v[168:169], v[12:13]
    v_pk_mul_f32 v[170:171], v[170:171], v[12:13]
    v_pk_mul_f32 v[172:173], v[172:173], v[12:13]
    v_pk_mul_f32 v[174:175], v[174:175], v[12:13]
    v_pk_mul_f32 v[176:177], v[176:177], v[12:13]
    v_pk_mul_f32 v[178:179], v[178:179], v[12:13]
    v_pk_mul_f32 v[180:181], v[180:181], v[12:13]
    v_pk_mul_f32 v[182:183], v[182:183], v[12:13]
    v_pk_fma_f32 v[224:225], v[168:169], v[168:169], v[10:11]
    v_pk_fma_f32 v[226:227], v[170:171], v[170:171], v[10:11]
    v_pk_fma_f32 v[228:229], v[172:173], v[172:173], v[10:11]
    v_pk_fma_f32 v[230:231], v[174:175], v[174:175], v[10:11]
    v_pk_fma_f32 v[184:185], v[176:177], v[176:177], v[10:11]
    v_pk_fma_f32 v[186:187], v[178:179], v[178:179], v[10:11]
    v_pk_fma_f32 v[188:189], v[180:181], v[180:181], v[10:11]
    v_pk_fma_f32 v[190:191], v[182:183], v[182:183], v[10:11]
    v_pk_mul_f32 v[224:225], v[224:225], v[168:169]
    v_pk_mul_f32 v[226:227], v[226:227], v[170:171]
    v_pk_mul_f32 v[228:229], v[228:229], v[172:173]
    v_pk_mul_f32 v[230:231], v[230:231], v[174:175]
    v_pk_mul_f32 v[184:185], v[184:185], v[176:177]
    v_pk_mul_f32 v[186:187], v[186:187], v[178:179]
    v_pk_mul_f32 v[188:189], v[188:189], v[180:181]
    v_pk_mul_f32 v[190:191], v[190:191], v[182:183]
    v_exp_f32 v224, v224
    v_exp_f32 v225, v225
    v_exp_f32 v226, v226
    v_exp_f32 v227, v227
    v_exp_f32 v228, v228
    v_exp_f32 v229, v229
    v_exp_f32 v230, v230
    v_exp_f32 v231, v231
    v_exp_f32 v184, v184
    v_exp_f32 v185, v185
    v_exp_f32 v186, v186
    v_exp_f32 v187, v187
    v_exp_f32 v188, v188
    v_exp_f32 v189, v189
    v_exp_f32 v190, v190
    v_exp_f32 v191, v191
    v_pk_add_f32 v[224:225], v[224:225], v[14:15]
    v_pk_add_f32 v[226:227], v[226:227], v[14:15]
    v_pk_add_f32 v[228:229], v[228:229], v[14:15]
    v_pk_add_f32 v[230:231], v[230:231], v[14:15]
    v_pk_add_f32 v[184:185], v[184:185], v[14:15]
    v_pk_add_f32 v[186:187], v[186:187], v[14:15]
    v_pk_add_f32 v[188:189], v[188:189], v[14:15]
    v_pk_add_f32 v[190:191], v[190:191], v[14:15]
    v_rcp_f32 v224, v224
    v_rcp_f32 v225, v225
    v_rcp_f32 v226, v226
    v_rcp_f32 v227, v227
    v_rcp_f32 v228, v228
    v_rcp_f32 v229, v229
    v_rcp_f32 v230, v230
    v_rcp_f32 v231, v231
    v_pk_mul_f32 v[224:225], v[224:225], v[168:169]
    v_pk_mul_f32 v[226:227], v[226:227], v[170:171]
    v_pk_mul_f32 v[228:229], v[228:229], v[172:173]
    v_pk_mul_f32 v[230:231], v[230:231], v[174:175]
    v_cvt_pk_bf16_f32 v168, v224, v225
    v_cvt_pk_bf16_f32 v169, v226, v227
    v_cvt_pk_bf16_f32 v170, v228, v229
    v_cvt_pk_bf16_f32 v171, v230, v231
    buffer_store_dwordx4 v[168:171], v246, s[28:31], s88 offen offset:0 sc1
    v_rcp_f32 v184, v184
    v_rcp_f32 v185, v185
    v_rcp_f32 v186, v186
    v_rcp_f32 v187, v187
    v_rcp_f32 v188, v188
    v_rcp_f32 v189, v189
    v_rcp_f32 v190, v190
    v_rcp_f32 v191, v191
    v_pk_mul_f32 v[184:185], v[184:185], v[176:177]
    v_pk_mul_f32 v[186:187], v[186:187], v[178:179]
    v_pk_mul_f32 v[188:189], v[188:189], v[180:181]
    v_pk_mul_f32 v[190:191], v[190:191], v[182:183]
    v_cvt_pk_bf16_f32 v176, v184, v185
    v_cvt_pk_bf16_f32 v177, v186, v187
    v_cvt_pk_bf16_f32 v178, v188, v189
    v_cvt_pk_bf16_f32 v179, v190, v191
    buffer_store_dwordx4 v[176:179], v246, s[28:31], s88 offen offset:1024 sc1
    s_branch L_p4_skip
L_p4_idle:
    s_and_b32 s72, s3, 3
    s_lshl_b32 s75, s72, 10
    s_lshl_b32 s72, s72, 11
    s_add_u32 s72, s72, s60
    s_add_u32 s76, s72, 6553600
    s_mov_b32 s88, s87
    s_barrier
    s_waitcnt vmcnt(0) lgkmcnt(0)
    s_barrier
L_p4_skip:
    s_cmp_lg_u32 s3, 0
    s_cbranch_scc1 L_w_40
    s_add_u32 s46, s99, 384
    s_load_dwordx8 s[48:55], s[64:65], s46 glc
    s_mov_b32 s44, s70
    s_mov_b32 s45, s70
    s_mov_b32 s47, 0
L_w_40:
    s_barrier
    s_add_u32 m0, s75, 49152
    s_add_u32 s79, s76, 49152
    buffer_load_dwordx4 v246, s[28:31], s79 offen sc1 lds
    s_add_u32 m0, s75, 53248
    s_add_u32 s79, s76, 229376
    buffer_load_dwordx4 v246, s[28:31], s79 offen sc1 lds
    s_add_u32 m0, s75, 57344
    s_add_u32 s79, s76, 50176
    buffer_load_dwordx4 v246, s[28:31], s79 offen sc1 lds
    s_add_u32 m0, s75, 61440
    s_add_u32 s79, s76, 230400
    buffer_load_dwordx4 v246, s[28:31], s79 offen sc1 lds
    s_cmp_lg_u32 s3, 0
    s_cbranch_scc1 L_w_41
L_sp_42:
    s_waitcnt lgkmcnt(0)
    s_xor_b64 s[48:49], s[48:49], s[44:45]
    s_xor_b64 s[50:51], s[50:51], s[44:45]
    s_xor_b64 s[52:53], s[52:53], s[44:45]
    s_xor_b64 s[54:55], s[54:55], s[44:45]
    s_or_b64 s[48:49], s[48:49], s[50:51]
    s_or_b64 s[48:49], s[48:49], s[52:53]
    s_or_b64 s[48:49], s[48:49], s[54:55]
    s_cbranch_scc0 L_spok_43
    s_load_dwordx8 s[48:55], s[64:65], s46 glc
    s_add_u32 s47, s47, 1
    s_cmp_lt_u32 s47, 16
    s_cbranch_scc1 L_sp_42
    s_waitcnt lgkmcnt(0)
    v_not_b32 v247, v248
    v_cmp_eq_u32 vcc, v247, v248
    s_nop 0
    s_and_b32 s79, vcc_lo, 0xff
    s_cmp_eq_u32 s79, 0xff
    s_cbranch_scc1 L_skip_44
    s_mov_b32 exec_hi, 0
    s_mov_b32 exec_lo, 0xff
    s_mov_b32 s93, 0
L_poll_45:
    buffer_load_dword v247, v249, s[28:31], s99 offen offset:384 sc1
    s_add_u32 s93, s93, 1
    s_waitcnt vmcnt(0)
    v_cmp_eq_u32 vcc, v247, v248
    s_cmp_gt_u32 s93, 200000
    s_cbranch_scc1 L_done_46
    s_cmp_eq_u64 vcc, exec
    s_cbranch_scc0 L_poll_45
L_done_46:
    s_mov_b64 exec, -1
L_skip_44:
L_spok_43:
L_w_41:
    s_waitcnt vmcnt(4)
    s_barrier
    s_cmp_lg_u32 s3, 0
    s_cbranch_scc1 L_nf_47
    s_mov_b64 exec, 1
    buffer_store_dword v248, v249, s[28:31], s98 offen offset:512 sc1
    s_mov_b64 exec, -1
L_nf_47:
    s_add_u32 m0, s75, 65536
    s_add_u32 s79, s76, 65536
    buffer_load_dwordx4 v246, s[28:31], s79 offen sc1 lds
    s_add_u32 m0, s75, 69632
    s_add_u32 s79, s76, 245760
    buffer_load_dwordx4 v246, s[28:31], s79 offen sc1 lds
    s_add_u32 m0, s75, 73728
    s_add_u32 s79, s76, 66560
    buffer_load_dwordx4 v246, s[28:31], s79 offen sc1 lds
    s_add_u32 m0, s75, 77824
    s_add_u32 s79, s76, 246784
    buffer_load_dwordx4 v246, s[28:31], s79 offen sc1 lds
    s_add_u32 m0, s75, 81920
    s_add_u32 s79, s76, 81920
    buffer_load_dwordx4 v246, s[28:31], s79 offen sc1 lds
    s_add_u32 m0, s75, 86016
    s_add_u32 s79, s76, 262144
    buffer_load_dwordx4 v246, s[28:31], s79 offen sc1 lds
    s_add_u32 m0, s75, 90112
    s_add_u32 s79, s76, 82944
    buffer_load_dwordx4 v246, s[28:31], s79 offen sc1 lds
    s_add_u32 m0, s75, 94208
    s_add_u32 s79, s76, 263168
    buffer_load_dwordx4 v246, s[28:31], s79 offen sc1 lds
    s_waitcnt vmcnt(8)
    s_barrier
    s_add_u32 m0, s75, 98304
    s_add_u32 s79, s76, 98304
    buffer_load_dwordx4 v246, s[28:31], s79 offen sc1 lds
    s_add_u32 m0, s75, 102400
    s_add_u32 s79, s76, 278528
    buffer_load_dwordx4 v246, s[28:31], s79 offen sc1 lds
    s_add_u32 m0, s75, 106496
    s_add_u32 s79, s76, 99328
    buffer_load_dwordx4 v246, s[28:31], s79 offen sc1 lds
    s_add_u32 m0, s75, 110592
    s_add_u32 s79, s76, 279552
    buffer_load_dwordx4 v246, s[28:31], s79 offen sc1 lds
    s_waitcnt vmcnt(8)
    s_barrier
    s_add_u32 m0, s75, 114688
    s_add_u32 s79, s76, 114688
    buffer_load_dwordx4 v246, s[28:31], s79 offen sc1 lds
    s_add_u32 m0, s75, 118784
    s_add_u32 s79, s76, 294912
    buffer_load_dwordx4 v246, s[28:31], s79 offen sc1 lds
    s_add_u32 m0, s75, 122880
    s_add_u32 s79, s76, 115712
    buffer_load_dwordx4 v246, s[28:31], s79 offen sc1 lds
    s_add_u32 m0, s75, 126976
    s_add_u32 s79, s76, 295936
    buffer_load_dwordx4 v246, s[28:31], s79 offen sc1 lds
    s_waitcnt vmcnt(8)
    s_barrier
    s_cmp_lg_u32 s3, 0
    s_cbranch_scc1 L_w_48
    s_add_u32 s46, s99, 512
    s_load_dwordx8 s[48:55], s[64:65], s46 glc
    s_mov_b32 s44, s70
    s_mov_b32 s45, s70
    s_mov_b32 s47, 0
L_w_48:
    s_waitcnt vmcnt(4)
    s_barrier
    s_cmp_lg_u32 s3, 0
    s_cbranch_scc1 L_w_49
L_sp_50:
    s_waitcnt lgkmcnt(0)
    s_xor_b64 s[48:49], s[48:49], s[44:45]
    s_xor_b64 s[50:51], s[50:51], s[44:45]
    s_xor_b64 s[52:53], s[52:53], s[44:45]
    s_xor_b64 s[54:55], s[54:55], s[44:45]
    s_or_b64 s[48:49], s[48:49], s[50:51]
    s_or_b64 s[48:49], s[48:49], s[52:53]
    s_or_b64 s[48:49], s[48:49], s[54:55]
    s_cbranch_scc0 L_spok_51
    s_load_dwordx8 s[48:55], s[64:65], s46 glc
    s_add_u32 s47, s47, 1
    s_cmp_lt_u32 s47, 16
    s_cbranch_scc1 L_sp_50
    s_waitcnt lgkmcnt(0)
    v_not_b32 v247, v248
    v_cmp_eq_u32 vcc, v247, v248
    s_nop 0
    s_and_b32 s79, vcc_lo, 0xff
    s_cmp_eq_u32 s79, 0xff
    s_cbranch_scc1 L_skip_52
    s_mov_b32 exec_hi, 0
    s_mov_b32 exec_lo, 0xff
    s_mov_b32 s93, 0
L_poll_53:
    buffer_load_dword v247, v249, s[28:31], s99 offen offset:512 sc1
    s_add_u32 s93, s93, 1
    s_waitcnt vmcnt(0)
    v_cmp_eq_u32 vcc, v247, v248
    s_cmp_gt_u32 s93, 200000
    s_cbranch_scc1 L_done_54
    s_cmp_eq_u64 vcc, exec
    s_cbranch_scc0 L_poll_53
L_done_54:
    s_mov_b64 exec, -1
L_skip_52:
L_spok_51:
L_w_49:
    s_waitcnt vmcnt(0)
    s_barrier
    s_add_u32 m0, s75, 131072
    s_add_u32 s79, s76, 131072
    buffer_load_dwordx4 v246, s[28:31], s79 offen sc1 lds
    s_add_u32 m0, s75, 135168
    s_add_u32 s79, s76, 311296
    buffer_load_dwordx4 v246, s[28:31], s79 offen sc1 lds
    s_add_u32 m0, s75, 139264
    s_add_u32 s79, s76, 132096
    buffer_load_dwordx4 v246, s[28:31], s79 offen sc1 lds
    s_add_u32 m0, s75, 143360
    s_add_u32 s79, s76, 312320
    buffer_load_dwordx4 v246, s[28:31], s79 offen sc1 lds
    s_add_u32 m0, s75, 147456
    s_add_u32 s79, s76, 147456
    buffer_load_dwordx4 v246, s[28:31], s79 offen sc1 lds
    s_add_u32 m0, s75, 151552
    s_add_u32 s79, s76, 327680
    buffer_load_dwordx4 v246, s[28:31], s79 offen sc1 lds
    s_add_u32 m0, s75, 155648
    s_add_u32 s79, s76, 148480
    buffer_load_dwordx4 v246, s[28:31], s79 offen sc1 lds
    s_add_u32 m0, s75, 159744
    s_add_u32 s79, s76, 328704
    buffer_load_dwordx4 v246, s[28:31], s79 offen sc1 lds
    s_cmp_eq_u32 s3, 3
    s_cselect_b32 s79, 2048, 0
    s_sub_u32 s76, s76, s79
    s_add_u32 m0, s75, 32768
    s_add_u32 s79, s76, 163840
    buffer_load_dwordx4 v246, s[28:31], s79 offen sc1 lds
    s_add_u32 m0, s75, 36864
    s_add_u32 s79, s76, 344064
    buffer_load_dwordx4 v246, s[28:31], s79 offen sc1 lds
    s_add_u32 m0, s75, 40960
    s_add_u32 s79, s76, 164864
    buffer_load_dwordx4 v246, s[28:31], s79 offen sc1 lds
    s_add_u32 m0, s75, 45056
    s_add_u32 s79, s76, 345088
    buffer_load_dwordx4 v246, s[28:31], s79 offen sc1 lds
    s_waitcnt vmcnt(8)
    s_barrier
    s_waitcnt vmcnt(4)
    s_barrier
    s_waitcnt vmcnt(0)
    s_barrier
    v_lshlrev_b32 v140, 16, v252
    v_and_b32 v141, 0xffff0000, v252
    v_lshlrev_b32 v142, 16, v253
    v_and_b32 v143, 0xffff0000, v253
    v_lshlrev_b32 v144, 16, v254
    v_and_b32 v145, 0xffff0000, v254
    v_lshlrev_b32 v146, 16, v255
    v_and_b32 v147, 0xffff0000, v255
    v_lshlrev_b32 v148, 16, v236
    v_and_b32 v149, 0xffff0000, v236
    v_lshlrev_b32 v150, 16, v237
    v_and_b32 v151, 0xffff0000, v237
    v_lshlrev_b32 v152, 16, v238
    v_and_b32 v153, 0xffff0000, v238
    v_lshlrev_b32 v154, 16, v239
    v_and_b32 v155, 0xffff0000, v239
    v_add_f32 v140, v140, v148
    v_add_f32 v141, v141, v149
    v_add_f32 v142, v142, v150
    v_add_f32 v143, v143, v151
    v_add_f32 v144, v144, v152
    v_add_f32 v145, v145, v153
    v_add_f32 v146, v146, v154
    v_add_f32 v147, v147, v155
    v_mov_b32 v10, 0xc0088e99
    v_mov_b32 v11, v10
L_p5_done:
    s_barrier
    ds_read_b128 v[16:19], v244
    ds_read_b128 v[24:27], v244 offset:16384
    ds_read_b128 v[20:23], v245
    ds_read_b128 v[28:31], v245 offset:16384
    s_waitcnt lgkmcnt(2)
    v_pk_add_f32 v[16:17], v[16:17], v[24:25]
    v_pk_fma_f32 v[140:141], v[16:17], v[10:11], v[140:141]
    v_pk_add_f32 v[18:19], v[18:19], v[26:27]
    v_pk_fma_f32 v[142:143], v[18:19], v[10:11], v[142:143]
    v_cvt_pk_bf16_f32 v40, v140, v141
    v_cvt_pk_bf16_f32 v41, v142, v143
    s_waitcnt lgkmcnt(0)
    v_pk_add_f32 v[20:21], v[20:21], v[28:29]
    v_pk_fma_f32 v[144:145], v[20:21], v[10:11], v[144:145]
    v_pk_add_f32 v[22:23], v[22:23], v[30:31]
    v_pk_fma_f32 v[146:147], v[22:23], v[10:11], v[146:147]
    v_cvt_pk_bf16_f32 v42, v144, v145
    v_cvt_pk_bf16_f32 v43, v146, v147
    buffer_store_dwordx4 v[40:43], v2, s[32:35], s83 offen sc0 sc1
L_end:
    s_endpgm
L_code_end:
L_attn_fb:
    s_waitcnt vmcnt(0)
    v_mov_b32 v40, 0xff800000
    s_mov_b32 s81, 0
    s_mov_b32 s80, 64
L_fb1:
    buffer_load_dwordx4 v[88:91], v15, s[28:31], s81 offen sc1
    s_waitcnt vmcnt(0)
    v_mfma_f32_32x32x16_bf16 v[24:39], v[88:91], v[20:23], 0
    s_add_u32 s81, s81, 2048
    s_nop 7
    s_nop 3
    v_max3_f32 v40, v40, v24, v25
    v_max3_f32 v40, v40, v26, v27
    v_max3_f32 v40, v40, v28, v29
    v_max3_f32 v40, v40, v30, v31
    v_max3_f32 v40, v40, v32, v33
    v_max3_f32 v40, v40, v34, v35
    v_max3_f32 v40, v40, v36, v37
    v_max3_f32 v40, v40, v38, v39
    s_sub_u32 s80, s80, 1
    s_cmp_lg_u32 s80, 0
    s_cbranch_scc1 L_fb1
    v_mov_b32 v41, v40
    s_nop 1
    v_permlane32_swap_b32 v40, v41
    s_nop 1
    v_max_f32 v40, v40, v41
    v_mov_b32 v72, 0
    v_mov_b32 v73, 0
    v_mov_b32 v74, 0
    v_mov_b32 v75, 0
    v_mov_b32 v76, 0
    v_mov_b32 v77, 0
    v_mov_b32 v78, 0
    v_mov_b32 v79, 0
    v_mov_b32 v80, 0
    v_mov_b32 v81, 0
    v_mov_b32 v82, 0
    v_mov_b32 v83, 0
    v_mov_b32 v84, 0
    v_mov_b32 v85, 0
    v_mov_b32 v86, 0
    v_mov_b32 v87, 0
    s_mov_b32 s81, 0
    s_mov_b32 s80, 64
L_fb2:
    buffer_load_dwordx4 v[88:91], v15, s[28:31], s81 offen offset:0 sc1
    s_mov_b64 exec, s[84:85]
    buffer_load_dwordx4 v[92:95], v14, s[28:31], s81 offen offset:1024 sc1
    buffer_load_dwordx4 v[96:99], v14, s[28:31], s81 offen offset:1536 sc1
    s_mov_b64 exec, -1
    s_waitcnt vmcnt(0)
    v_mfma_f32_32x32x16_bf16 v[24:39], v[88:91], v[20:23], 0
    s_add_u32 s81, s81, 2048
    s_nop 7
    s_nop 3
    v_sub_f32 v24, v24, v40
    v_sub_f32 v25, v25, v40
    v_sub_f32 v26, v26, v40
    v_sub_f32 v27, v27, v40
    v_sub_f32 v28, v28, v40
    v_sub_f32 v29, v29, v40
    v_sub_f32 v30, v30, v40
    v_sub_f32 v31, v31, v40
    v_sub_f32 v32, v32, v40
    v_sub_f32 v33, v33, v40
    v_sub_f32 v34, v34, v40
    v_sub_f32 v35, v35, v40
    v_sub_f32 v36, v36, v40
    v_sub_f32 v37, v37, v40
    v_sub_f32 v38, v38, v40
    v_sub_f32 v39, v39, v40
    v_exp_f32 v24, v24
    v_exp_f32 v25, v25
    v_exp_f32 v26, v26
    v_exp_f32 v27, v27
    v_exp_f32 v28, v28
    v_exp_f32 v29, v29
    v_exp_f32 v30, v30
    v_exp_f32 v31, v31
    v_exp_f32 v32, v32
    v_exp_f32 v33, v33
    v_exp_f32 v34, v34
    v_exp_f32 v35, v35
    v_exp_f32 v36, v36
    v_exp_f32 v37, v37
    v_exp_f32 v38, v38
    v_exp_f32 v39, v39
    s_nop 1
    v_smfmac_f32_32x32x32_bf16 v[72:87], v[92:95], v[24:31], v8
    v_smfmac_f32_32x32x32_bf16 v[72:87], v[96:99], v[32:39], v8
    s_sub_u32 s80, s80, 1
    s_cmp_lg_u32 s80, 0
    s_nop 7
    s_cbranch_scc1 L_fb2
    s_nop 7
    s_nop 3
    v_rcp_f32 v10, v80
    s_branch L_attn_fin
.section .rodata,"a"
.p2align 6
.amdhsa_kernel sequential_preLN__softmax_full_mha__dense_activation_gelu__prompt_kernel
  .amdhsa_next_free_vgpr 256
  .amdhsa_next_free_sgpr 102
  .amdhsa_accum_offset 256
  .amdhsa_group_segment_fixed_size 0
  .amdhsa_kernarg_size 88
  .amdhsa_user_sgpr_count 2
  .amdhsa_user_sgpr_kernarg_segment_ptr 1
  .amdhsa_system_sgpr_workgroup_id_x 1
.end_amdhsa_kernel
```
